```python
import torch

def _softmax(x, axis=-1):
    return torch.softmax(x, dim=axis)
def _gelu(x):
    return torch.nn.functional.gelu(x, approximate="tanh")
def _silu(x):
    return torch.nn.functional.silu(x)
def _sigmoid(x):
    return torch.sigmoid(x)
def _layernorm(x, axis=-1, eps=1e-5):
    m = x.mean(dim=axis, keepdim=True)
    v = x.var(dim=axis, keepdim=True, unbiased=False)
    return (x - m) / torch.sqrt(v + eps)
def _scatter_add(tgt, idx, src, axis=0):
    return tgt.clone().index_add_(axis, idx, src)
def _segment_sum(src, seg, n):
    out = torch.zeros((n,) + src.shape[1:], dtype=src.dtype)
    return out.index_add_(0, seg, src)
def _pad(x, pw):
    flat = tuple(v for pair in reversed(pw) for v in pair)
    return torch.nn.functional.pad(x, flat)

kernel_name = 'gated_mix__softmax_full_mha__sliding_block__prompt'

def setup_inputs():

    _w = (lambda a: (lambda t: t.to(torch.bfloat16) if t.is_floating_point() else t)(torch.as_tensor(a)))
    def _A_setup():
        B, S, D = 1, 2048, 512
        return {
            "x": _w((lambda *s: torch.randn(*s, dtype=torch.bfloat16) * 0.05)(B, S, D)),
            "wqkv": _w((lambda *s: torch.randn(*s, dtype=torch.bfloat16) * 1.6)(D, 3 * D)),
            "wo": _w((lambda *s: torch.randn(*s, dtype=torch.bfloat16) * 0.1)(D, D)),
        }
    _A_in = _A_setup()

    def _B_setup():
        B, S, D = 1, 2048, 512
        return {
            "x": _w((lambda *s: torch.randn(*s, dtype=torch.bfloat16) * 0.05)(B, S, D)),
            "wqkv": _w((lambda *s: torch.randn(*s, dtype=torch.bfloat16) * 1.6)(D, 3 * D)),
            "wo": _w((lambda *s: torch.randn(*s, dtype=torch.bfloat16) * 0.05)(D, D)),
        }
    _B_in = _B_setup()

    return {
        "A_x": _A_in["x"],
        "A_wqkv": _A_in["wqkv"],
        "A_wo": _A_in["wo"],
        "B_x": _B_in["x"],
        "B_wqkv": _B_in["wqkv"],
        "B_wo": _B_in["wo"],
        "gate_w": _w((lambda *s: torch.randn(*s, dtype=torch.bfloat16) * 0.05)(512) * 16.0),
    }

def reference(A_x, A_wqkv, A_wo, B_x, B_wqkv, B_wo, gate_w):
    def _A_ref(x, wqkv, wo):
        B, S, D = x.shape
        H = 32; Dh = D // H
        qkv = (lambda x, *d: x.permute(*d))((x @ wqkv).reshape(B, S, 3, H, Dh), 2, 0, 3, 1, 4)
        q, k, v = qkv[0], qkv[1], qkv[2]
        scale = Dh ** -0.5
        scores = torch.einsum("bhqd,bhkd->bhqk", q, k) * scale
        p = _softmax(scores, axis=-1)
        o = torch.einsum("bhqk,bhkd->bhqd", p, v)
        return (lambda x, *d: x.permute(*d))(o, 0, 2, 1, 3).reshape(B, S, D) @ wo

    def _B_ref(x, wqkv, wo):
        B, S, D = x.shape
        H = 32; Dh = D // H; W = 256
        qkv = (lambda x, *d: x.permute(*d))((x @ wqkv).reshape(B, S, 3, H, Dh), 2, 0, 3, 1, 4)
        q, k, v = qkv[0], qkv[1], qkv[2]
        scores = torch.einsum("bhqd,bhkd->bhqk", q, k) * (Dh ** -0.5)
        idx = torch.arange(S)
        mask = (idx[:, None] - idx[None, :] >= 0) & (idx[:, None] - idx[None, :] < W)
        scores = torch.where(mask[None, None], scores, -1e9)
        p = _softmax(scores, axis=-1)
        o = torch.einsum("bhqk,bhkd->bhqd", p, v)
        return (lambda x, *d: x.permute(*d))(o, 0, 2, 1, 3).reshape(B, S, D) @ wo

    x = A_x
    g = _sigmoid((x * gate_w).sum(-1, keepdims=True))
    a = _A_ref(x, A_wqkv, A_wo)
    b = _B_ref(x, B_wqkv, B_wo)
    return g * a + (1 - g) * b
```

```asm
; @launch grid=(256,1,1) block=(512,1,1) lds=163840
.amdgcn_target "amdgcn-amd-amdhsa--gfx950"
.text
.globl gated_mix__softmax_full_mha__sliding_block__prompt_kernel
.p2align 8
.type gated_mix__softmax_full_mha__sliding_block__prompt_kernel,@function
gated_mix__softmax_full_mha__sliding_block__prompt_kernel:
    s_cmp_ge_u32 s2, 256
    s_cbranch_scc1 L_done
    s_load_dwordx2 s[4:5], s[0:1], 72
    s_load_dwordx2 s[42:43], s[0:1], 0
    s_load_dwordx2 s[44:45], s[0:1], 8
    s_load_dwordx2 s[46:47], s[0:1], 32
    s_load_dwordx2 s[48:49], s[0:1], 48
    s_load_dwordx2 s[84:85], s[0:1], 16
    s_load_dwordx2 s[86:87], s[0:1], 40
    s_load_dwordx2 s[88:89], s[0:1], 56
    s_and_b32 s25, s2, 7
    s_lshr_b32 s26, s2, 3
    s_lshr_b32 s27, s26, 2
    s_and_b32 s28, s26, 3
    s_lshr_b32 s29, s28, 1
    s_and_b32 s50, s28, 1
    s_lshl_b32 s30, s27, 1
    s_add_u32 s30, s30, s50
    s_lshl_b32 s31, s25, 2
    s_add_u32 s31, s31, s28
    v_lshrrev_b32 v1, 6, v0
    v_and_b32 v2, 63, v0
    s_nop 0
    v_readfirstlane_b32 s24, v1
    s_waitcnt lgkmcnt(0)
    s_add_u32 s6, s4, 31457280
    s_addc_u32 s7, s5, 0
    s_load_dword s3, s[6:7], 0
    s_mov_b32 s8, s4
    s_mov_b32 s9, s5
    s_mov_b32 s10, 32505856
    s_mov_b32 s11, 0x00020000
    s_mov_b32 s12, s42
    s_mov_b32 s13, s43
    s_mov_b32 s14, 2097152
    s_mov_b32 s15, 0x00020000
    s_cmp_eq_u32 s29, 0
    s_cselect_b32 s44, s44, s46
    s_cselect_b32 s45, s45, s47
    s_mov_b32 s16, s44
    s_mov_b32 s17, s45
    s_mov_b32 s18, 1572864
    s_mov_b32 s19, 0x00020000
    s_mov_b32 s20, s48
    s_mov_b32 s21, s49
    s_mov_b32 s22, 1024
    s_mov_b32 s23, 0x00020000
    v_lshlrev_b32 v24, 4, v2
    s_cmp_lt_u32 s24, 4
    s_cbranch_scc1 P1_compute
P1_loader:
    s_and_b32 s34, s24, 3
    v_lshrrev_b32 v5, 3, v2
    v_and_b32 v7, 7, v2
    v_lshrrev_b32 v6, 4, v2
    v_xor_b32 v6, v6, v7
    s_lshl_b32 s42, s30, 7
    s_lshl_b32 s43, s34, 5
    s_add_u32 s42, s42, s43
    v_add_u32 v3, s42, v5
    v_lshlrev_b32 v3, 10, v3
    v_xor_b32 v9, 4, v6
    v_lshl_add_u32 v9, v9, 4, v3
    v_add_u32 v9, 8192, v9
    v_lshl_add_u32 v3, v6, 4, v3
    v_add_u32 v10, 0x4000, v3
    v_add_u32 v11, 0x4000, v9
    v_bfe_u32 v6, v2, 4, 1
    v_lshlrev_b32 v6, 1, v6
    v_xor_b32 v6, v6, v7
    s_lshl_b32 s43, s34, 4
    v_add_u32 v5, s43, v5
    v_mul_u32_u24 v4, 3072, v5
    s_lshl_b32 s45, s25, 7
    v_add_u32 v4, s45, v4
    v_xor_b32 v12, 4, v6
    v_lshl_add_u32 v12, v12, 4, v4
    v_add_u32 v12, 24576, v12
    v_lshl_add_u32 v4, v6, 4, v4
    s_lshr_b32 s60, s30, 1
    s_add_u32 s60, s60, s25
    s_mov_b32 s50, 0
    s_mov_b32 s49, 0
P1_lpro:
    s_and_b32 s51, s50, 3
    s_mul_i32 s51, s51, 40960
    s_lshl_b32 s46, s34, 12
    s_add_u32 s46, s46, s51
    s_lshl_b32 s57, s34, 11
    s_add_u32 s57, s57, s51
    s_add_u32 s59, s50, s60
    s_and_b32 s59, s59, 7
    s_lshl_b32 s47, s59, 7
    s_mul_i32 s48, s59, 196608
    s_add_u32 m0, s46, 0
    s_nop 0
    buffer_load_dwordx4 v3, s[12:15], s47 offen lds
    s_add_u32 m0, s46, 1024
    s_nop 0
    buffer_load_dwordx4 v9, s[12:15], s47 offen lds
    s_add_u32 m0, s46, 2048
    s_nop 0
    buffer_load_dwordx4 v10, s[12:15], s47 offen lds
    s_add_u32 m0, s46, 3072
    s_nop 0
    buffer_load_dwordx4 v11, s[12:15], s47 offen lds
    s_add_u32 m0, s57, 16384
    s_nop 0
    buffer_load_dwordx4 v4, s[16:19], s48 offen offset:0 lds
    s_add_u32 m0, s57, 17408
    s_nop 0
    buffer_load_dwordx4 v12, s[16:19], s48 offen offset:0 lds
    s_add_u32 m0, s57, 23552
    s_nop 0
    buffer_load_dwordx4 v4, s[16:19], s48 offen offset:1024 lds
    s_add_u32 m0, s57, 24576
    s_nop 0
    buffer_load_dwordx4 v12, s[16:19], s48 offen offset:1024 lds
    s_add_u32 m0, s57, 30720
    s_nop 0
    buffer_load_dwordx4 v4, s[16:19], s48 offen offset:2048 lds
    s_add_u32 m0, s57, 31744
    s_nop 0
    buffer_load_dwordx4 v12, s[16:19], s48 offen offset:2048 lds
    s_add_u32 s50, s50, 1
    s_cmp_lt_u32 s50, 3
    s_cbranch_scc1 P1_lpro
    s_lshl_b32 s62, s27, 8
    s_and_b32 s42, s24, 3
    s_lshl_b32 s42, s42, 6
    s_add_u32 s62, s62, s42
    s_lshl_b32 s42, s31, 1
    s_add_u32 s62, s62, s42
    s_lshr_b32 s42, s24, 2
    s_add_u32 s62, s62, s42
    s_lshl_b32 s42, s62, 10
    buffer_load_dwordx4 v[232:235], v24, s[12:15], s42 offen
    buffer_load_dwordx4 v[236:239], v24, s[20:23], 0 offen
    s_waitcnt vmcnt(22)
    s_barrier
    s_waitcnt lgkmcnt(0)
    s_mul_i32 s3, s3, 0x9e3779b1
    s_add_u32 s3, s3, 0x7f4a7c15
    v_lshrrev_b32 v5, 4, v2
    v_lshlrev_b32 v247, 22, v5
    v_bfe_u32 v5, v2, 3, 1
    v_lshl_add_u32 v247, v5, 10, v247
    v_and_b32 v5, 7, v2
    v_lshl_add_u32 v247, v5, 7, v247
    v_cmp_gt_u32 vcc, 48, v2
    v_mov_b32 v5, 0x7ff00000
    s_nop 0
    v_cndmask_b32 v247, v5, v247, vcc
    s_and_b32 s42, s34, 1
    s_lshr_b32 s43, s34, 1
    s_lshl_b32 s44, s25, 2
    s_lshl_b32 s43, s43, 1
    s_add_u32 s44, s44, s43
    s_lshl_b32 s43, s29, 5
    s_add_u32 s44, s44, s43
    s_lshl_b32 s44, s44, 16
    s_lshl_b32 s43, s30, 1
    s_add_u32 s43, s43, s42
    s_lshl_b32 s43, s43, 11
    s_add_u32 s56, s44, s43
P1_lpro2:
    s_and_b32 s51, s50, 3
    s_mul_i32 s51, s51, 40960
    s_lshl_b32 s46, s34, 12
    s_add_u32 s46, s46, s51
    s_lshl_b32 s57, s34, 11
    s_add_u32 s57, s57, s51
    s_add_u32 s59, s50, s60
    s_and_b32 s59, s59, 7
    s_lshl_b32 s47, s59, 7
    s_mul_i32 s48, s59, 196608
    s_add_u32 m0, s46, 0
    s_nop 0
    buffer_load_dwordx4 v3, s[12:15], s47 offen lds
    s_add_u32 m0, s46, 1024
    s_nop 0
    buffer_load_dwordx4 v9, s[12:15], s47 offen lds
    s_add_u32 m0, s46, 2048
    s_nop 0
    buffer_load_dwordx4 v10, s[12:15], s47 offen lds
    s_add_u32 m0, s46, 3072
    s_nop 0
    buffer_load_dwordx4 v11, s[12:15], s47 offen lds
    s_add_u32 m0, s57, 16384
    s_nop 0
    buffer_load_dwordx4 v4, s[16:19], s48 offen offset:0 lds
    s_add_u32 m0, s57, 17408
    s_nop 0
    buffer_load_dwordx4 v12, s[16:19], s48 offen offset:0 lds
    s_add_u32 m0, s57, 23552
    s_nop 0
    buffer_load_dwordx4 v4, s[16:19], s48 offen offset:1024 lds
    s_add_u32 m0, s57, 24576
    s_nop 0
    buffer_load_dwordx4 v12, s[16:19], s48 offen offset:1024 lds
    s_add_u32 m0, s57, 30720
    s_nop 0
    buffer_load_dwordx4 v4, s[16:19], s48 offen offset:2048 lds
    s_add_u32 m0, s57, 31744
    s_nop 0
    buffer_load_dwordx4 v12, s[16:19], s48 offen offset:2048 lds
    s_add_u32 s50, s50, 1
    s_cmp_lt_u32 s50, 4
    s_cbranch_scc1 P1_lpro2
P1_lloop:
    s_cmp_lt_u32 s49, 5
    s_cbranch_scc0 P1_ltail
    s_waitcnt vmcnt(20)
    s_branch P1_lbar
P1_ltail:
    s_cmp_eq_u32 s49, 5
    s_cbranch_scc0 P1_ltail2
    s_waitcnt vmcnt(10)
    s_branch P1_lbar
P1_ltail2:
    s_cmp_eq_u32 s49, 6
    s_cbranch_scc0 P1_lbar
    s_waitcnt vmcnt(2)
P1_lbar:
    s_barrier
    s_cmp_lt_u32 s50, 8
    s_cbranch_scc0 P1_lnoiss
    s_and_b32 s51, s50, 3
    s_mul_i32 s51, s51, 40960
    s_lshl_b32 s46, s34, 12
    s_add_u32 s46, s46, s51
    s_lshl_b32 s57, s34, 11
    s_add_u32 s57, s57, s51
    s_add_u32 s59, s50, s60
    s_and_b32 s59, s59, 7
    s_lshl_b32 s47, s59, 7
    s_mul_i32 s48, s59, 196608
    s_add_u32 m0, s46, 0
    s_nop 0
    buffer_load_dwordx4 v3, s[12:15], s47 offen lds
    s_add_u32 m0, s46, 1024
    s_nop 0
    buffer_load_dwordx4 v9, s[12:15], s47 offen lds
    s_add_u32 m0, s46, 2048
    s_nop 0
    buffer_load_dwordx4 v10, s[12:15], s47 offen lds
    s_add_u32 m0, s46, 3072
    s_nop 0
    buffer_load_dwordx4 v11, s[12:15], s47 offen lds
    s_add_u32 m0, s57, 16384
    s_nop 0
    buffer_load_dwordx4 v4, s[16:19], s48 offen offset:0 lds
    s_add_u32 m0, s57, 17408
    s_nop 0
    buffer_load_dwordx4 v12, s[16:19], s48 offen offset:0 lds
    s_add_u32 m0, s57, 23552
    s_nop 0
    buffer_load_dwordx4 v4, s[16:19], s48 offen offset:1024 lds
    s_add_u32 m0, s57, 24576
    s_nop 0
    buffer_load_dwordx4 v12, s[16:19], s48 offen offset:1024 lds
    s_add_u32 m0, s57, 30720
    s_nop 0
    buffer_load_dwordx4 v4, s[16:19], s48 offen offset:2048 lds
    s_add_u32 m0, s57, 31744
    s_nop 0
    buffer_load_dwordx4 v12, s[16:19], s48 offen offset:2048 lds
    s_add_u32 s50, s50, 1
P1_lnoiss:
    s_cmp_eq_u32 s49, 5
    s_cbranch_scc0 P1_lnopt
    s_add_u32 s42, s56, 65536
    buffer_load_dword v240, v247, s[8:11], s56 offen sc1
    buffer_load_dword v241, v247, s[8:11], s42 offen sc1
P1_lnopt:
    s_add_u32 s49, s49, 1
    s_cmp_lt_u32 s49, 8
    s_cbranch_scc1 P1_lloop
    s_mov_b32 s39, 0
    s_branch P1_join
P1_compute:
    s_lshl_b32 s62, s27, 8
    s_and_b32 s42, s24, 3
    s_lshl_b32 s42, s42, 6
    s_add_u32 s62, s62, s42
    s_lshl_b32 s42, s31, 1
    s_add_u32 s62, s62, s42
    s_lshr_b32 s42, s24, 2
    s_add_u32 s62, s62, s42
    s_lshl_b32 s42, s62, 10
    buffer_load_dwordx4 v[232:235], v24, s[12:15], s42 offen
    buffer_load_dwordx4 v[236:239], v24, s[20:23], 0 offen
    s_and_b32 s34, s24, 1
    s_lshr_b32 s35, s24, 1
    s_lshl_b32 s42, s25, 2
    s_lshl_b32 s43, s35, 1
    s_add_u32 s42, s42, s43
    s_lshl_b32 s43, s29, 5
    s_add_u32 s42, s42, s43
    s_lshl_b32 s42, s42, 16
    s_lshl_b32 s43, s30, 1
    s_add_u32 s43, s43, s34
    s_lshl_b32 s43, s43, 11
    s_add_u32 s56, s42, s43
    v_and_b32 v246, 31, v2
    v_lshlrev_b32 v246, 2, v246
    v_lshrrev_b32 v5, 5, v2
    v_lshl_add_u32 v246, v5, 10, v246
    s_lshl_b32 s58, s25, 7
    s_add_u32 s58, s58, 31458304
    s_getreg_b32 s37, hwreg(HW_REG_XCC_ID, 0, 4)
    v_lshrrev_b32 v8, 4, v2
    v_and_b32 v20, 15, v2
    v_lshrrev_b32 v5, 1, v20
    s_lshl_b32 s42, s34, 6
    v_add_u32 v6, s42, v20
    v_lshlrev_b32 v6, 7, v6
    v_or_b32 v7, 0, v8
    v_xor_b32 v7, v7, v5
    v_lshl_add_u32 v10, v7, 4, v6
    v_or_b32 v7, 4, v8
    v_xor_b32 v7, v7, v5
    v_lshl_add_u32 v11, v7, 4, v6
    v_bfe_u32 v5, v2, 2, 2
    v_lshl_add_u32 v6, v8, 3, v5
    v_lshlrev_b32 v6, 7, v6
    v_and_b32 v21, 1, v2
    v_lshl_add_u32 v6, v21, 3, v6
    v_add_u32 v6, 16384, v6
    v_bfe_u32 v7, v2, 3, 1
    v_bfe_u32 v21, v2, 4, 1
    v_lshl_or_b32 v7, v21, 1, v7
    v_lshlrev_b32 v7, 1, v7
    v_bfe_u32 v21, v2, 1, 1
    s_lshl_b32 s42, s35, 2
    v_or_b32 v21, s42, v21
    v_or_b32 v22, 0, v21
    v_xor_b32 v22, v7, v22
    v_lshl_add_u32 v18, v22, 4, v6
    v_or_b32 v22, 2, v21
    v_xor_b32 v22, v7, v22
    v_lshl_add_u32 v19, v22, 4, v6
    v_mov_b32 v32, 0
    v_mov_b32 v33, 0
    v_mov_b32 v34, 0
    v_mov_b32 v35, 0
    v_mov_b32 v36, 0
    v_mov_b32 v37, 0
    v_mov_b32 v38, 0
    v_mov_b32 v39, 0
    v_mov_b32 v40, 0
    v_mov_b32 v41, 0
    v_mov_b32 v42, 0
    v_mov_b32 v43, 0
    v_mov_b32 v44, 0
    v_mov_b32 v45, 0
    v_mov_b32 v46, 0
    v_mov_b32 v47, 0
    v_mov_b32 v48, 0
    v_mov_b32 v49, 0
    v_mov_b32 v50, 0
    v_mov_b32 v51, 0
    v_mov_b32 v52, 0
    v_mov_b32 v53, 0
    v_mov_b32 v54, 0
    v_mov_b32 v55, 0
    v_mov_b32 v56, 0
    v_mov_b32 v57, 0
    v_mov_b32 v58, 0
    v_mov_b32 v59, 0
    v_mov_b32 v60, 0
    v_mov_b32 v61, 0
    v_mov_b32 v62, 0
    v_mov_b32 v63, 0
    v_mov_b32 v64, 0
    v_mov_b32 v65, 0
    v_mov_b32 v66, 0
    v_mov_b32 v67, 0
    v_mov_b32 v68, 0
    v_mov_b32 v69, 0
    v_mov_b32 v70, 0
    v_mov_b32 v71, 0
    v_mov_b32 v72, 0
    v_mov_b32 v73, 0
    v_mov_b32 v74, 0
    v_mov_b32 v75, 0
    v_mov_b32 v76, 0
    v_mov_b32 v77, 0
    v_mov_b32 v78, 0
    v_mov_b32 v79, 0
    v_mov_b32 v80, 0
    v_mov_b32 v81, 0
    v_mov_b32 v82, 0
    v_mov_b32 v83, 0
    v_mov_b32 v84, 0
    v_mov_b32 v85, 0
    v_mov_b32 v86, 0
    v_mov_b32 v87, 0
    v_mov_b32 v88, 0
    v_mov_b32 v89, 0
    v_mov_b32 v90, 0
    v_mov_b32 v91, 0
    v_mov_b32 v92, 0
    v_mov_b32 v93, 0
    v_mov_b32 v94, 0
    v_mov_b32 v95, 0
    v_mov_b32 v96, 0
    v_mov_b32 v97, 0
    v_mov_b32 v98, 0
    v_mov_b32 v99, 0
    v_mov_b32 v100, 0
    v_mov_b32 v101, 0
    v_mov_b32 v102, 0
    v_mov_b32 v103, 0
    v_mov_b32 v104, 0
    v_mov_b32 v105, 0
    v_mov_b32 v106, 0
    v_mov_b32 v107, 0
    v_mov_b32 v108, 0
    v_mov_b32 v109, 0
    v_mov_b32 v110, 0
    v_mov_b32 v111, 0
    v_mov_b32 v112, 0
    v_mov_b32 v113, 0
    v_mov_b32 v114, 0
    v_mov_b32 v115, 0
    v_mov_b32 v116, 0
    v_mov_b32 v117, 0
    v_mov_b32 v118, 0
    v_mov_b32 v119, 0
    v_mov_b32 v120, 0
    v_mov_b32 v121, 0
    v_mov_b32 v122, 0
    v_mov_b32 v123, 0
    v_mov_b32 v124, 0
    v_mov_b32 v125, 0
    v_mov_b32 v126, 0
    v_mov_b32 v127, 0
    s_mov_b32 s49, 0
    s_mov_b32 s36, 0
    s_mov_b32 s53, 40960
    s_barrier
    s_waitcnt lgkmcnt(0)
    s_mul_i32 s3, s3, 0x9e3779b1
    s_add_u32 s3, s3, 0x7f4a7c15
    ds_read_b64_tr_b16 v[160:161], v18 offset:0
    ds_read_b64_tr_b16 v[162:163], v18 offset:512
    ds_read_b128 v[128:131], v10 offset:0
    ds_read_b128 v[132:135], v10 offset:2048
    ds_read_b64_tr_b16 v[164:165], v18 offset:8192
    ds_read_b64_tr_b16 v[166:167], v18 offset:8704
    ds_read_b128 v[136:139], v10 offset:4096
    ds_read_b128 v[140:143], v10 offset:6144
    ds_read_b64_tr_b16 v[168:169], v18 offset:16384
    ds_read_b64_tr_b16 v[170:171], v18 offset:16896
    s_cmp_lg_u32 s24, 0
    s_cbranch_scc1 L_f0_nf
    s_add_u32 s42, s3, s37
    s_lshl_b32 s43, s26, 2
    s_add_u32 s43, s43, s58
    v_mov_b32 v5, s42
    v_mov_b32 v6, 0
    s_mov_b64 exec, 1
    buffer_store_dword v5, v6, s[8:11], s43 offen sc1
    s_mov_b64 exec, -1
L_f0_nf:
.p2align 3
P1_loop:
    s_waitcnt lgkmcnt(7)
    v_mfma_f32_16x16x32_bf16 v[32:35], v[160:163], v[128:131], v[32:35]
    s_waitcnt lgkmcnt(6)
    v_mfma_f32_16x16x32_bf16 v[36:39], v[160:163], v[132:135], v[36:39]
    s_waitcnt lgkmcnt(4)
    v_mfma_f32_16x16x32_bf16 v[48:51], v[164:167], v[128:131], v[48:51]
    ds_read_b64_tr_b16 v[172:173], v19 offset:0
    v_mfma_f32_16x16x32_bf16 v[52:55], v[164:167], v[132:135], v[52:55]
    ds_read_b64_tr_b16 v[174:175], v19 offset:512
    s_waitcnt lgkmcnt(5)
    v_mfma_f32_16x16x32_bf16 v[40:43], v[160:163], v[136:139], v[40:43]
    ds_read_b64_tr_b16 v[176:177], v19 offset:8192
    s_waitcnt lgkmcnt(5)
    v_mfma_f32_16x16x32_bf16 v[44:47], v[160:163], v[140:143], v[44:47]
    ds_read_b64_tr_b16 v[178:179], v19 offset:8704
    v_mfma_f32_16x16x32_bf16 v[56:59], v[164:167], v[136:139], v[56:59]
    ds_read_b64_tr_b16 v[180:181], v19 offset:16384
    v_mfma_f32_16x16x32_bf16 v[60:63], v[164:167], v[140:143], v[60:63]
    ds_read_b64_tr_b16 v[182:183], v19 offset:16896
    s_waitcnt lgkmcnt(6)
    v_mfma_f32_16x16x32_bf16 v[64:67], v[128:131], v[168:171], v[64:67]
    v_mfma_f32_16x16x32_bf16 v[68:71], v[132:135], v[168:171], v[68:71]
    v_mfma_f32_16x16x32_bf16 v[72:75], v[136:139], v[168:171], v[72:75]
    v_mfma_f32_16x16x32_bf16 v[76:79], v[140:143], v[168:171], v[76:79]
    s_waitcnt lgkmcnt(4)
    v_mfma_f32_16x16x32_bf16 v[80:83], v[172:175], v[128:131], v[80:83]
    v_mfma_f32_16x16x32_bf16 v[84:87], v[172:175], v[132:135], v[84:87]
    ds_read_b64_tr_b16 v[160:161], v18 offset:4096
    s_waitcnt lgkmcnt(3)
    v_mfma_f32_16x16x32_bf16 v[96:99], v[176:179], v[128:131], v[96:99]
    ds_read_b64_tr_b16 v[162:163], v18 offset:4608
    v_mfma_f32_16x16x32_bf16 v[100:103], v[176:179], v[132:135], v[100:103]
    ds_read_b128 v[144:147], v11 offset:0
    v_mfma_f32_16x16x32_bf16 v[88:91], v[172:175], v[136:139], v[88:91]
    ds_read_b128 v[148:151], v11 offset:2048
    v_mfma_f32_16x16x32_bf16 v[92:95], v[172:175], v[140:143], v[92:95]
    ds_read_b64_tr_b16 v[164:165], v18 offset:12288
    v_mfma_f32_16x16x32_bf16 v[104:107], v[176:179], v[136:139], v[104:107]
    ds_read_b64_tr_b16 v[166:167], v18 offset:12800
    v_mfma_f32_16x16x32_bf16 v[108:111], v[176:179], v[140:143], v[108:111]
    ds_read_b128 v[152:155], v11 offset:4096
    s_waitcnt lgkmcnt(7)
    v_mfma_f32_16x16x32_bf16 v[112:115], v[128:131], v[180:183], v[112:115]
    ds_read_b128 v[156:159], v11 offset:6144
    v_mfma_f32_16x16x32_bf16 v[116:119], v[132:135], v[180:183], v[116:119]
    ds_read_b64_tr_b16 v[168:169], v18 offset:20480
    v_mfma_f32_16x16x32_bf16 v[120:123], v[136:139], v[180:183], v[120:123]
    ds_read_b64_tr_b16 v[170:171], v18 offset:20992
    v_mfma_f32_16x16x32_bf16 v[124:127], v[140:143], v[180:183], v[124:127]
    s_waitcnt lgkmcnt(7)
    v_mfma_f32_16x16x32_bf16 v[32:35], v[160:163], v[144:147], v[32:35]
    s_waitcnt lgkmcnt(6)
    v_mfma_f32_16x16x32_bf16 v[36:39], v[160:163], v[148:151], v[36:39]
    s_waitcnt lgkmcnt(4)
    v_mfma_f32_16x16x32_bf16 v[48:51], v[164:167], v[144:147], v[48:51]
    ds_read_b64_tr_b16 v[172:173], v19 offset:4096
    v_mfma_f32_16x16x32_bf16 v[52:55], v[164:167], v[148:151], v[52:55]
    ds_read_b64_tr_b16 v[174:175], v19 offset:4608
    s_waitcnt lgkmcnt(5)
    v_mfma_f32_16x16x32_bf16 v[40:43], v[160:163], v[152:155], v[40:43]
    ds_read_b64_tr_b16 v[176:177], v19 offset:12288
    s_waitcnt lgkmcnt(5)
    v_mfma_f32_16x16x32_bf16 v[44:47], v[160:163], v[156:159], v[44:47]
    ds_read_b64_tr_b16 v[178:179], v19 offset:12800
    v_mfma_f32_16x16x32_bf16 v[56:59], v[164:167], v[152:155], v[56:59]
    ds_read_b64_tr_b16 v[180:181], v19 offset:20480
    v_mfma_f32_16x16x32_bf16 v[60:63], v[164:167], v[156:159], v[60:63]
    ds_read_b64_tr_b16 v[182:183], v19 offset:20992
    s_waitcnt lgkmcnt(6)
    v_mfma_f32_16x16x32_bf16 v[64:67], v[144:147], v[168:171], v[64:67]
    v_mfma_f32_16x16x32_bf16 v[68:71], v[148:151], v[168:171], v[68:71]
    v_mfma_f32_16x16x32_bf16 v[72:75], v[152:155], v[168:171], v[72:75]
    v_mfma_f32_16x16x32_bf16 v[76:79], v[156:159], v[168:171], v[76:79]
    s_waitcnt lgkmcnt(4)
    v_mfma_f32_16x16x32_bf16 v[80:83], v[172:175], v[144:147], v[80:83]
    v_mfma_f32_16x16x32_bf16 v[84:87], v[172:175], v[148:151], v[84:87]
    s_waitcnt lgkmcnt(2)
    v_mfma_f32_16x16x32_bf16 v[96:99], v[176:179], v[144:147], v[96:99]
    s_add_u32 s36, s36, 1
    s_cmp_eq_u32 s36, 4
    s_cselect_b32 s52, 0xfffe2000, s53
    s_cselect_b32 s36, 0, s36
    s_waitcnt lgkmcnt(0)
    v_add_u32 v10, s52, v10
    v_add_u32 v11, s52, v11
    v_add_u32 v18, s52, v18
    v_add_u32 v19, s52, v19
    s_cmp_eq_u32 s49, 4
    s_cbranch_scc1 P1_f0ld
P1_f0back:
    s_barrier
    v_mfma_f32_16x16x32_bf16 v[100:103], v[176:179], v[148:151], v[100:103]
    ds_read_b64_tr_b16 v[160:161], v18 offset:0
    ds_read_b64_tr_b16 v[162:163], v18 offset:512
    v_mfma_f32_16x16x32_bf16 v[88:91], v[172:175], v[152:155], v[88:91]
    ds_read_b128 v[128:131], v10 offset:0
    ds_read_b128 v[132:135], v10 offset:2048
    v_mfma_f32_16x16x32_bf16 v[92:95], v[172:175], v[156:159], v[92:95]
    ds_read_b64_tr_b16 v[164:165], v18 offset:8192
    v_mfma_f32_16x16x32_bf16 v[104:107], v[176:179], v[152:155], v[104:107]
    ds_read_b64_tr_b16 v[166:167], v18 offset:8704
    v_mfma_f32_16x16x32_bf16 v[108:111], v[176:179], v[156:159], v[108:111]
    ds_read_b128 v[136:139], v10 offset:4096
    s_waitcnt lgkmcnt(7)
    v_mfma_f32_16x16x32_bf16 v[112:115], v[144:147], v[180:183], v[112:115]
    ds_read_b128 v[140:143], v10 offset:6144
    v_mfma_f32_16x16x32_bf16 v[116:119], v[148:151], v[180:183], v[116:119]
    ds_read_b64_tr_b16 v[168:169], v18 offset:16384
    v_mfma_f32_16x16x32_bf16 v[120:123], v[152:155], v[180:183], v[120:123]
    ds_read_b64_tr_b16 v[170:171], v18 offset:16896
    v_mfma_f32_16x16x32_bf16 v[124:127], v[156:159], v[180:183], v[124:127]
    s_add_u32 s49, s49, 1
    s_cmp_lt_u32 s49, 8
    s_cbranch_scc1 P1_loop
    s_branch P1_after
P1_f0ld:
    buffer_load_dword v244, v246, s[8:11], s58 offen sc1
    s_branch P1_f0back
P1_after:
    s_waitcnt vmcnt(0)
    s_mov_b32 s42, 1048576
P1_chk:
    v_subrev_u32 v245, s3, v244
    v_cmp_gt_u32 vcc, 8, v245
    s_nop 1
    s_cmp_eq_u32 vcc_lo, -1
    s_cbranch_scc1 P1_chk_ok
    s_sub_u32 s42, s42, 1
    s_cmp_eq_u32 s42, 0
    s_cbranch_scc1 P1_chk_ok
    s_sleep 1
    buffer_load_dword v244, v246, s[8:11], s58 offen sc1
    s_waitcnt vmcnt(0)
    s_branch P1_chk
P1_chk_ok:
    v_cmp_eq_u32 vcc, s37, v245
    s_nop 1
    s_cmp_eq_u32 vcc_lo, -1
    s_cselect_b32 s39, 1, 0
    s_mov_b32 s44, 0x3eb8aa3b
    s_mov_b32 s48, s44
    s_mov_b32 s49, s44
    s_waitcnt lgkmcnt(0)
    v_cvt_pk_bf16_f32 v128, v48, v49
    v_cvt_pk_bf16_f32 v129, v50, v51
    v_cvt_pk_bf16_f32 v130, v52, v53
    v_cvt_pk_bf16_f32 v131, v54, v55
    v_cvt_pk_bf16_f32 v132, v56, v57
    v_cvt_pk_bf16_f32 v133, v58, v59
    v_cvt_pk_bf16_f32 v134, v60, v61
    v_cvt_pk_bf16_f32 v135, v62, v63
    v_cvt_pk_bf16_f32 v136, v64, v65
    v_cvt_pk_bf16_f32 v137, v66, v67
    v_cvt_pk_bf16_f32 v138, v68, v69
    v_cvt_pk_bf16_f32 v139, v70, v71
    v_cvt_pk_bf16_f32 v140, v72, v73
    v_cvt_pk_bf16_f32 v141, v74, v75
    v_cvt_pk_bf16_f32 v142, v76, v77
    v_cvt_pk_bf16_f32 v143, v78, v79
    v_pk_mul_f32 v[32:33], v[32:33], s[48:49]
    v_pk_mul_f32 v[34:35], v[34:35], s[48:49]
    v_pk_mul_f32 v[36:37], v[36:37], s[48:49]
    v_pk_mul_f32 v[38:39], v[38:39], s[48:49]
    v_pk_mul_f32 v[40:41], v[40:41], s[48:49]
    v_pk_mul_f32 v[42:43], v[42:43], s[48:49]
    v_pk_mul_f32 v[44:45], v[44:45], s[48:49]
    v_pk_mul_f32 v[46:47], v[46:47], s[48:49]
    v_permlane16_swap_b32 v128, v130
    v_permlane16_swap_b32 v129, v131
    v_permlane16_swap_b32 v132, v134
    v_permlane16_swap_b32 v133, v135
    v_cvt_pk_bf16_f32 v144, v32, v33
    v_cvt_pk_bf16_f32 v145, v34, v35
    v_cvt_pk_bf16_f32 v146, v36, v37
    v_cvt_pk_bf16_f32 v147, v38, v39
    v_cvt_pk_bf16_f32 v148, v40, v41
    v_cvt_pk_bf16_f32 v149, v42, v43
    v_cvt_pk_bf16_f32 v150, v44, v45
    v_cvt_pk_bf16_f32 v151, v46, v47
    v_permlane32_swap_b32 v136, v138
    v_permlane32_swap_b32 v137, v139
    v_permlane32_swap_b32 v140, v142
    v_permlane32_swap_b32 v141, v143
    v_permlane16_swap_b32 v144, v146
    v_permlane16_swap_b32 v145, v147
    v_permlane16_swap_b32 v148, v150
    v_permlane16_swap_b32 v149, v151
    s_add_u32 s46, s56, 0
    s_add_u32 s45, s46, 4194304
    s_add_u32 s47, s46, 8388608
    s_cmp_eq_u32 s39, 0
    s_cbranch_scc1 P1_st_safe0
    buffer_store_dwordx4 v[128:131], v24, s[8:11], s45 offen
    buffer_store_dwordx4 v[132:135], v24, s[8:11], s45 offen offset:1024
    buffer_store_dwordx4 v[136:139], v24, s[8:11], s47 offen
    buffer_store_dwordx4 v[140:143], v24, s[8:11], s47 offen offset:1024
    buffer_store_dwordx4 v[144:147], v24, s[8:11], s46 offen
    buffer_store_dwordx4 v[148:151], v24, s[8:11], s46 offen offset:1024
P1_st_done0:
    v_cvt_pk_bf16_f32 v152, v96, v97
    v_cvt_pk_bf16_f32 v153, v98, v99
    v_cvt_pk_bf16_f32 v154, v100, v101
    v_cvt_pk_bf16_f32 v155, v102, v103
    v_cvt_pk_bf16_f32 v156, v104, v105
    v_cvt_pk_bf16_f32 v157, v106, v107
    v_cvt_pk_bf16_f32 v158, v108, v109
    v_cvt_pk_bf16_f32 v159, v110, v111
    v_cvt_pk_bf16_f32 v160, v112, v113
    v_cvt_pk_bf16_f32 v161, v114, v115
    v_cvt_pk_bf16_f32 v162, v116, v117
    v_cvt_pk_bf16_f32 v163, v118, v119
    v_cvt_pk_bf16_f32 v164, v120, v121
    v_cvt_pk_bf16_f32 v165, v122, v123
    v_cvt_pk_bf16_f32 v166, v124, v125
    v_cvt_pk_bf16_f32 v167, v126, v127
    v_pk_mul_f32 v[80:81], v[80:81], s[48:49]
    v_pk_mul_f32 v[82:83], v[82:83], s[48:49]
    v_pk_mul_f32 v[84:85], v[84:85], s[48:49]
    v_pk_mul_f32 v[86:87], v[86:87], s[48:49]
    v_pk_mul_f32 v[88:89], v[88:89], s[48:49]
    v_pk_mul_f32 v[90:91], v[90:91], s[48:49]
    v_pk_mul_f32 v[92:93], v[92:93], s[48:49]
    v_pk_mul_f32 v[94:95], v[94:95], s[48:49]
    v_permlane16_swap_b32 v152, v154
    v_permlane16_swap_b32 v153, v155
    v_permlane16_swap_b32 v156, v158
    v_permlane16_swap_b32 v157, v159
    v_cvt_pk_bf16_f32 v168, v80, v81
    v_cvt_pk_bf16_f32 v169, v82, v83
    v_cvt_pk_bf16_f32 v170, v84, v85
    v_cvt_pk_bf16_f32 v171, v86, v87
    v_cvt_pk_bf16_f32 v172, v88, v89
    v_cvt_pk_bf16_f32 v173, v90, v91
    v_cvt_pk_bf16_f32 v174, v92, v93
    v_cvt_pk_bf16_f32 v175, v94, v95
    v_permlane32_swap_b32 v160, v162
    v_permlane32_swap_b32 v161, v163
    v_permlane32_swap_b32 v164, v166
    v_permlane32_swap_b32 v165, v167
    v_permlane16_swap_b32 v168, v170
    v_permlane16_swap_b32 v169, v171
    v_permlane16_swap_b32 v172, v174
    v_permlane16_swap_b32 v173, v175
    s_add_u32 s46, s56, 65536
    s_add_u32 s45, s46, 4194304
    s_add_u32 s47, s46, 8388608
    s_cmp_eq_u32 s39, 0
    s_cbranch_scc1 P1_st_safe1
    buffer_store_dwordx4 v[152:155], v24, s[8:11], s45 offen
    buffer_store_dwordx4 v[156:159], v24, s[8:11], s45 offen offset:1024
    buffer_store_dwordx4 v[160:163], v24, s[8:11], s47 offen
    buffer_store_dwordx4 v[164:167], v24, s[8:11], s47 offen offset:1024
    buffer_store_dwordx4 v[168:171], v24, s[8:11], s46 offen
    buffer_store_dwordx4 v[172:175], v24, s[8:11], s46 offen offset:1024
P1_st_done1:
P1_join:
    s_nop 1
    v_and_b32 v1, 63, v0
    v_lshlrev_b32 v174, 4, v1
    v_and_b32 v175, 31, v1
    s_mov_b32 s40, 0x0000ffff
    s_mov_b32 s41, 0x0000ffff
    v_cmp_eq_u32 vcc, 16, v175
    v_mov_b32 v182, 0x3f803f80
    s_nop 0
    v_cndmask_b32 v183, 0, v182, vcc
    v_mov_b32 v210, v183
    v_mov_b32 v211, v183
    v_mov_b32 v212, v183
    v_mov_b32 v213, v183
    v_mov_b32 v214, v183
    v_mov_b32 v215, v183
    v_mov_b32 v216, v183
    v_mov_b32 v217, v183
    v_mov_b32 v218, v183
    v_mov_b32 v219, v183
    v_mov_b32 v220, v183
    v_mov_b32 v221, v183
    v_mov_b32 v222, v183
    v_mov_b32 v223, v183
    v_mov_b32 v224, v183
    v_mov_b32 v225, v183
    v_lshrrev_b32 v177, 5, v1
    v_lshlrev_b32 v176, 2, v177
    v_sub_u32 v176, v175, v176
    v_mov_b32 v182, 0xf1800000
    v_cmp_gt_i32 s[82:83], 0, v176
    v_cmp_gt_i32 s[90:91], 1, v176
    v_cmp_gt_i32 s[96:97], 2, v176
    v_cmp_gt_i32 s[98:99], 3, v176
    s_nop 0
    v_cndmask_b32 v140, v182, 0, s[82:83]
    v_cndmask_b32 v156, 0, v182, s[82:83]
    v_cndmask_b32 v141, v182, 0, s[90:91]
    v_cndmask_b32 v157, 0, v182, s[90:91]
    v_cndmask_b32 v142, v182, 0, s[96:97]
    v_cndmask_b32 v158, 0, v182, s[96:97]
    v_cndmask_b32 v143, v182, 0, s[98:99]
    v_cndmask_b32 v159, 0, v182, s[98:99]
    v_cmp_gt_i32 s[82:83], 8, v176
    v_cmp_gt_i32 s[90:91], 9, v176
    v_cmp_gt_i32 s[96:97], 10, v176
    v_cmp_gt_i32 s[98:99], 11, v176
    s_nop 0
    v_cndmask_b32 v144, v182, 0, s[82:83]
    v_cndmask_b32 v160, 0, v182, s[82:83]
    v_cndmask_b32 v145, v182, 0, s[90:91]
    v_cndmask_b32 v161, 0, v182, s[90:91]
    v_cndmask_b32 v146, v182, 0, s[96:97]
    v_cndmask_b32 v162, 0, v182, s[96:97]
    v_cndmask_b32 v147, v182, 0, s[98:99]
    v_cndmask_b32 v163, 0, v182, s[98:99]
    v_cmp_gt_i32 s[82:83], 16, v176
    v_cmp_gt_i32 s[90:91], 17, v176
    v_cmp_gt_i32 s[96:97], 18, v176
    v_cmp_gt_i32 s[98:99], 19, v176
    s_nop 0
    v_cndmask_b32 v148, v182, 0, s[82:83]
    v_cndmask_b32 v164, 0, v182, s[82:83]
    v_cndmask_b32 v149, v182, 0, s[90:91]
    v_cndmask_b32 v165, 0, v182, s[90:91]
    v_cndmask_b32 v150, v182, 0, s[96:97]
    v_cndmask_b32 v166, 0, v182, s[96:97]
    v_cndmask_b32 v151, v182, 0, s[98:99]
    v_cndmask_b32 v167, 0, v182, s[98:99]
    v_cmp_gt_i32 s[82:83], 24, v176
    v_cmp_gt_i32 s[90:91], 25, v176
    v_cmp_gt_i32 s[96:97], 26, v176
    v_cmp_gt_i32 s[98:99], 27, v176
    s_nop 0
    v_cndmask_b32 v152, v182, 0, s[82:83]
    v_cndmask_b32 v168, 0, v182, s[82:83]
    v_cndmask_b32 v153, v182, 0, s[90:91]
    v_cndmask_b32 v169, 0, v182, s[90:91]
    v_cndmask_b32 v154, v182, 0, s[96:97]
    v_cndmask_b32 v170, 0, v182, s[96:97]
    v_cndmask_b32 v155, v182, 0, s[98:99]
    v_cndmask_b32 v171, 0, v182, s[98:99]
    v_and_b32 v175, 15, v1
    v_lshlrev_b32 v175, 4, v175
    v_lshl_add_u32 v188, v177, 8, v175
    s_and_b32 s15, s24, 3
    s_lshr_b32 s16, s24, 2
    s_lshl_b32 s17, s15, 1
    s_add_u32 s17, s17, s16
    s_lshl_b32 s18, s27, 3
    s_add_u32 s19, s18, s17
    s_lshl_b32 s20, s31, 16
    s_add_u32 s21, s20, 2097152
    s_lshl_b32 s43, s17, 10
    s_add_u32 s44, s43, 131072
    v_add_u32 v172, s44, v174
    s_add_u32 s44, s43, 147456
    v_add_u32 v173, s44, v188
    s_lshl_b32 s32, s19, 16
    s_lshl_b32 s33, s31, 10
    s_add_u32 s32, s32, s33
    s_add_u32 s32, s32, 16777216
    s_add_u32 s33, s32, 32768
    s_lshl_b32 s22, s19, 10
    s_add_u32 s22, s22, s21
    s_add_u32 s22, s22, 0
    s_lshl_b32 s23, s19, 10
    s_add_u32 s23, s23, s20
    s_add_u32 s23, s23, 0
    s_xor_b32 s14, s19, 1
    s_lshl_b32 s14, s14, 10
    s_add_u32 s14, s14, s20
    s_add_u32 s14, s14, 0
    s_add_u32 s43, s24, 0
    s_add_u32 s44, s18, s43
    s_sub_u32 s44, s44, 8
    s_max_i32 s44, s44, 0
    s_lshl_b32 s44, s44, 10
    s_add_u32 s44, s44, s21
    s_add_u32 s54, s44, 4194304
    s_add_u32 s43, s24, 8
    s_add_u32 s44, s18, s43
    s_sub_u32 s44, s44, 8
    s_max_i32 s44, s44, 0
    s_lshl_b32 s44, s44, 10
    s_add_u32 s44, s44, s21
    s_add_u32 s55, s44, 4194304
    s_lshl_b32 s56, s24, 10
    s_add_u32 s57, s56, s20
    s_add_u32 s57, s57, 4194304
    s_waitcnt vmcnt(0)
    s_barrier
    s_lshl_b32 s42, s25, 7
    s_lshl_b32 s43, s26, 2
    s_add_u32 s43, s43, s42
    s_add_u32 s43, s43, 31459328
    s_add_u32 s38, s42, 31459328
    s_cmp_eq_u32 s39, 0
    s_cbranch_scc1 L_f1_safe
    s_cmp_lg_u32 s24, 0
    s_cbranch_scc1 L_f1f_nf
    v_mov_b32 v5, s3
    v_mov_b32 v6, 0
    s_mov_b64 exec, 1
    buffer_store_dword v5, v6, s[8:11], s43 offen
    s_mov_b64 exec, -1
L_f1f_nf:
    s_branch L_f1_done
L_f1_safe:
    s_cmp_lg_u32 s24, 0
    s_cbranch_scc1 L_f1s_nf
    v_mov_b32 v5, s3
    v_mov_b32 v6, 0
    s_mov_b64 exec, 1
    buffer_store_dword v5, v6, s[8:11], s43 offen sc1
    s_mov_b64 exec, -1
L_f1s_nf:
L_f1_done:
    v_mov_b32 v16, 0
    v_mov_b32 v17, 0
    v_mov_b32 v18, 0
    v_mov_b32 v19, 0
    v_mov_b32 v20, 0
    v_mov_b32 v21, 0
    v_mov_b32 v22, 0
    v_mov_b32 v23, 0
    v_mov_b32 v24, 0
    v_mov_b32 v25, 0
    v_mov_b32 v26, 0
    v_mov_b32 v27, 0
    v_mov_b32 v28, 0
    v_mov_b32 v29, 0
    v_mov_b32 v30, 0
    v_mov_b32 v31, 0
    v_mov_b32 v84, 0
    v_mov_b32 v85, 0
    v_mov_b32 v86, 0
    v_mov_b32 v87, 0
    v_mov_b32 v250, 0
    v_dot2_f32_bf16 v250, v232, v236, v250
    v_dot2_f32_bf16 v250, v233, v237, v250
    v_dot2_f32_bf16 v250, v234, v238, v250
    v_dot2_f32_bf16 v250, v235, v239, v250
    s_nop 2
    v_add_f32_dpp v250, v250, v250 row_ror:8 row_mask:0xf bank_mask:0xf
    s_nop 1
    v_add_f32_dpp v250, v250, v250 row_ror:4 row_mask:0xf bank_mask:0xf
    s_nop 1
    v_add_f32_dpp v250, v250, v250 row_ror:2 row_mask:0xf bank_mask:0xf
    s_nop 1
    v_add_f32_dpp v250, v250, v250 row_ror:1 row_mask:0xf bank_mask:0xf
    s_nop 1
    v_mov_b32 v251, v250
    s_nop 1
    v_permlane16_swap_b32 v251, v250
    s_nop 1
    v_add_f32 v250, v250, v251
    v_mov_b32 v251, v250
    s_nop 1
    v_permlane32_swap_b32 v251, v250
    s_nop 1
    v_add_f32 v250, v250, v251
    v_mul_f32 v250, 0xbfb8aa3b, v250
    v_exp_f32 v250, v250
    s_nop 0
    v_add_f32 v250, 1.0, v250
    v_rcp_f32 v250, v250
    s_lshl_b32 s62, s62, 2
    s_add_u32 s62, s62, 12582912
    v_mov_b32 v251, 0
    s_cmp_lg_u32 s24, 0
    s_cbranch_scc1 L_p1_skip
    v_and_b32 v2, 31, v0
    v_mul_u32_u24 v2, 4, v2
    s_mov_b32 s42, 1048576
L_p1_loop:
    buffer_load_dword v3, v2, s[8:11], s38 offen sc1
    s_waitcnt vmcnt(0)
    v_cmp_ne_u32 vcc, s3, v3
    s_nop 1
    s_cmp_eq_u64 vcc, 0
    s_cbranch_scc1 L_p1_skip
    s_sub_u32 s42, s42, 1
    s_cmp_eq_u32 s42, 0
    s_cbranch_scc1 L_p1_skip
    s_sleep 1
    s_branch L_p1_loop
L_p1_skip:
    s_barrier
    buffer_load_dwordx4 v[12:15], v174, s[8:11], s22 offen sc1
    s_add_u32 m0, s56, 131072
    s_add_u32 s45, s54, 4194304
    buffer_load_dwordx4 v174, s[8:11], s54 offen sc1 lds
    s_add_u32 m0, s56, 147456
    s_nop 0
    buffer_load_dwordx4 v174, s[8:11], s45 offen sc1 lds
    s_add_u32 m0, s56, 139264
    s_add_u32 s45, s55, 4194304
    buffer_load_dwordx4 v174, s[8:11], s55 offen sc1 lds
    s_add_u32 m0, s56, 155648
    s_nop 0
    buffer_load_dwordx4 v174, s[8:11], s45 offen sc1 lds
    buffer_load_dwordx4 v[4:7], v174, s[8:11], s23 offen sc1
    buffer_load_dwordx4 v[8:11], v174, s[8:11], s14 offen sc1
    s_waitcnt vmcnt(2)
    s_barrier
    s_mov_b32 s51, 1
    s_cmp_eq_u32 s27, 0
    s_cselect_b32 s50, 0, 1
    s_sub_u32 s53, 8, s17
    s_cmp_eq_u32 s27, 0
    s_cselect_b32 s53, s53, 0
    s_sub_u32 s52, 9, s53
    s_lshl_b32 s43, s53, 10
    v_add_u32 v180, s43, v172
    v_add_u32 v181, s43, v173
    s_cmp_lg_u32 s53, 0
    s_cbranch_scc1 B_jump
B_pro0:
    ds_read_b128 v[88:91], v172 offset:0
    s_waitcnt lgkmcnt(0)
    v_mfma_f32_32x32x16_bf16 v[48:63], v[88:91], v[12:15], v[140:155]
    s_mov_b64 exec, s[40:41]
    ds_read_b128 v[210:213], v173 offset:0
    ds_read_b128 v[214:217], v173 offset:512
    s_mov_b64 exec, -1
    ds_read_b128 v[92:95], v172 offset:1024
    s_nop 7
    s_nop 3
B_step0:
    s_setprio 3
    s_waitcnt lgkmcnt(0)
    v_mfma_f32_32x32x16_bf16 v[64:79], v[92:95], v[12:15], 0
    v_exp_f32 v48, v48
    v_exp_f32 v49, v49
    v_exp_f32 v50, v50
    v_exp_f32 v51, v51
    v_cvt_pk_bf16_f32 v80, v48, v49
    v_exp_f32 v52, v52
    v_exp_f32 v53, v53
    v_cvt_pk_bf16_f32 v81, v50, v51
    ds_read_b128 v[88:91], v172 offset:2048
    s_mov_b64 exec, s[40:41]
    ds_read_b128 v[218:221], v173 offset:1024
    ds_read_b128 v[222:225], v173 offset:1536
    s_mov_b64 exec, -1
    s_add_u32 m0, s56, 0
    s_add_u32 s45, s57, 0
    buffer_load_dwordx4 v174, s[8:11], s45 offen sc1 lds
    s_add_u32 m0, s56, 65536
    s_add_u32 s45, s57, 4194304
    buffer_load_dwordx4 v174, s[8:11], s45 offen sc1 lds
    v_exp_f32 v54, v54
    v_exp_f32 v55, v55
    v_cvt_pk_bf16_f32 v82, v52, v53
    v_exp_f32 v56, v56
    v_exp_f32 v57, v57
    v_cvt_pk_bf16_f32 v83, v54, v55
    v_exp_f32 v58, v58
    v_exp_f32 v59, v59
    s_waitcnt lgkmcnt(3)
    v_mfma_f32_32x32x16_bf16 v[16:31], v[210:213], v[80:83], v[16:31]
    v_exp_f32 v60, v60
    v_cvt_pk_bf16_f32 v84, v56, v57
    v_exp_f32 v61, v61
    v_exp_f32 v62, v62
    v_cvt_pk_bf16_f32 v85, v58, v59
    v_exp_f32 v63, v63
    v_cvt_pk_bf16_f32 v86, v60, v61
    v_cvt_pk_bf16_f32 v87, v62, v63
B_step1:
    s_waitcnt lgkmcnt(2)
    v_mfma_f32_32x32x16_bf16 v[48:63], v[88:91], v[12:15], 0
    v_exp_f32 v64, v64
    v_exp_f32 v65, v65
    v_exp_f32 v66, v66
    v_exp_f32 v67, v67
    v_cvt_pk_bf16_f32 v80, v64, v65
    v_exp_f32 v68, v68
    v_exp_f32 v69, v69
    v_cvt_pk_bf16_f32 v81, v66, v67
    v_mfma_f32_32x32x16_bf16 v[16:31], v[214:217], v[84:87], v[16:31]
    ds_read_b128 v[92:95], v172 offset:3072
    s_mov_b64 exec, s[40:41]
    ds_read_b128 v[210:213], v173 offset:2048
    ds_read_b128 v[214:217], v173 offset:2560
    s_mov_b64 exec, -1
    s_add_u32 m0, s56, 8192
    s_add_u32 s45, s57, 8192
    buffer_load_dwordx4 v174, s[8:11], s45 offen sc1 lds
    s_add_u32 m0, s56, 73728
    s_add_u32 s45, s57, 4202496
    buffer_load_dwordx4 v174, s[8:11], s45 offen sc1 lds
    v_exp_f32 v70, v70
    v_exp_f32 v71, v71
    v_cvt_pk_bf16_f32 v82, v68, v69
    v_exp_f32 v72, v72
    v_exp_f32 v73, v73
    v_cvt_pk_bf16_f32 v83, v70, v71
    v_exp_f32 v74, v74
    v_exp_f32 v75, v75
    s_waitcnt lgkmcnt(3)
    v_mfma_f32_32x32x16_bf16 v[16:31], v[218:221], v[80:83], v[16:31]
    v_exp_f32 v76, v76
    v_cvt_pk_bf16_f32 v84, v72, v73
    v_exp_f32 v77, v77
    v_exp_f32 v78, v78
    v_cvt_pk_bf16_f32 v85, v74, v75
    v_exp_f32 v79, v79
    v_cvt_pk_bf16_f32 v86, v76, v77
    v_cvt_pk_bf16_f32 v87, v78, v79
B_step2:
    s_waitcnt lgkmcnt(2)
    v_mfma_f32_32x32x16_bf16 v[64:79], v[92:95], v[12:15], 0
    v_exp_f32 v48, v48
    v_exp_f32 v49, v49
    v_exp_f32 v50, v50
    v_exp_f32 v51, v51
    v_cvt_pk_bf16_f32 v80, v48, v49
    v_exp_f32 v52, v52
    v_exp_f32 v53, v53
    v_cvt_pk_bf16_f32 v81, v50, v51
    v_mfma_f32_32x32x16_bf16 v[16:31], v[222:225], v[84:87], v[16:31]
    ds_read_b128 v[88:91], v172 offset:4096
    s_mov_b64 exec, s[40:41]
    ds_read_b128 v[218:221], v173 offset:3072
    ds_read_b128 v[222:225], v173 offset:3584
    s_mov_b64 exec, -1
    s_add_u32 m0, s56, 16384
    s_add_u32 s45, s57, 16384
    buffer_load_dwordx4 v174, s[8:11], s45 offen sc1 lds
    s_add_u32 m0, s56, 81920
    s_add_u32 s45, s57, 4210688
    buffer_load_dwordx4 v174, s[8:11], s45 offen sc1 lds
    v_exp_f32 v54, v54
    v_exp_f32 v55, v55
    v_cvt_pk_bf16_f32 v82, v52, v53
    v_exp_f32 v56, v56
    v_exp_f32 v57, v57
    v_cvt_pk_bf16_f32 v83, v54, v55
    v_exp_f32 v58, v58
    v_exp_f32 v59, v59
    s_waitcnt lgkmcnt(3)
    v_mfma_f32_32x32x16_bf16 v[16:31], v[210:213], v[80:83], v[16:31]
    v_exp_f32 v60, v60
    v_cvt_pk_bf16_f32 v84, v56, v57
    v_exp_f32 v61, v61
    v_exp_f32 v62, v62
    v_cvt_pk_bf16_f32 v85, v58, v59
    v_exp_f32 v63, v63
    v_cvt_pk_bf16_f32 v86, v60, v61
    v_cvt_pk_bf16_f32 v87, v62, v63
B_step3:
    s_setprio 2
    s_waitcnt lgkmcnt(2)
    v_mfma_f32_32x32x16_bf16 v[48:63], v[88:91], v[12:15], 0
    v_exp_f32 v64, v64
    v_exp_f32 v65, v65
    v_exp_f32 v66, v66
    v_exp_f32 v67, v67
    v_cvt_pk_bf16_f32 v80, v64, v65
    v_exp_f32 v68, v68
    v_exp_f32 v69, v69
    v_cvt_pk_bf16_f32 v81, v66, v67
    v_mfma_f32_32x32x16_bf16 v[16:31], v[214:217], v[84:87], v[16:31]
    ds_read_b128 v[92:95], v172 offset:5120
    s_mov_b64 exec, s[40:41]
    ds_read_b128 v[210:213], v173 offset:4096
    ds_read_b128 v[214:217], v173 offset:4608
    s_mov_b64 exec, -1
    s_add_u32 m0, s56, 24576
    s_add_u32 s45, s57, 24576
    buffer_load_dwordx4 v174, s[8:11], s45 offen sc1 lds
    s_add_u32 m0, s56, 90112
    s_add_u32 s45, s57, 4218880
    buffer_load_dwordx4 v174, s[8:11], s45 offen sc1 lds
    v_exp_f32 v70, v70
    v_exp_f32 v71, v71
    v_cvt_pk_bf16_f32 v82, v68, v69
    v_exp_f32 v72, v72
    v_exp_f32 v73, v73
    v_cvt_pk_bf16_f32 v83, v70, v71
    v_exp_f32 v74, v74
    v_exp_f32 v75, v75
    s_waitcnt lgkmcnt(3)
    v_mfma_f32_32x32x16_bf16 v[16:31], v[218:221], v[80:83], v[16:31]
    v_exp_f32 v76, v76
    v_cvt_pk_bf16_f32 v84, v72, v73
    v_exp_f32 v77, v77
    v_exp_f32 v78, v78
    v_cvt_pk_bf16_f32 v85, v74, v75
    v_exp_f32 v79, v79
    v_cvt_pk_bf16_f32 v86, v76, v77
    v_cvt_pk_bf16_f32 v87, v78, v79
B_step4:
    s_waitcnt lgkmcnt(2)
    v_mfma_f32_32x32x16_bf16 v[64:79], v[92:95], v[12:15], 0
    v_exp_f32 v48, v48
    v_exp_f32 v49, v49
    v_exp_f32 v50, v50
    v_exp_f32 v51, v51
    v_cvt_pk_bf16_f32 v80, v48, v49
    v_exp_f32 v52, v52
    v_exp_f32 v53, v53
    v_cvt_pk_bf16_f32 v81, v50, v51
    v_mfma_f32_32x32x16_bf16 v[16:31], v[222:225], v[84:87], v[16:31]
    ds_read_b128 v[88:91], v172 offset:6144
    s_mov_b64 exec, s[40:41]
    ds_read_b128 v[218:221], v173 offset:5120
    ds_read_b128 v[222:225], v173 offset:5632
    s_mov_b64 exec, -1
    s_add_u32 m0, s56, 32768
    s_add_u32 s45, s57, 32768
    buffer_load_dwordx4 v174, s[8:11], s45 offen sc1 lds
    s_add_u32 m0, s56, 98304
    s_add_u32 s45, s57, 4227072
    buffer_load_dwordx4 v174, s[8:11], s45 offen sc1 lds
    v_exp_f32 v54, v54
    v_exp_f32 v55, v55
    v_cvt_pk_bf16_f32 v82, v52, v53
    v_exp_f32 v56, v56
    v_exp_f32 v57, v57
    v_cvt_pk_bf16_f32 v83, v54, v55
    v_exp_f32 v58, v58
    v_exp_f32 v59, v59
    s_waitcnt lgkmcnt(3)
    v_mfma_f32_32x32x16_bf16 v[16:31], v[210:213], v[80:83], v[16:31]
    v_exp_f32 v60, v60
    v_cvt_pk_bf16_f32 v84, v56, v57
    v_exp_f32 v61, v61
    v_exp_f32 v62, v62
    v_cvt_pk_bf16_f32 v85, v58, v59
    v_exp_f32 v63, v63
    v_cvt_pk_bf16_f32 v86, v60, v61
    v_cvt_pk_bf16_f32 v87, v62, v63
B_step5:
    s_setprio 1
    s_waitcnt lgkmcnt(2)
    v_mfma_f32_32x32x16_bf16 v[48:63], v[88:91], v[12:15], 0
    v_exp_f32 v64, v64
    v_exp_f32 v65, v65
    v_exp_f32 v66, v66
    v_exp_f32 v67, v67
    v_cvt_pk_bf16_f32 v80, v64, v65
    v_exp_f32 v68, v68
    v_exp_f32 v69, v69
    v_cvt_pk_bf16_f32 v81, v66, v67
    v_mfma_f32_32x32x16_bf16 v[16:31], v[214:217], v[84:87], v[16:31]
    ds_read_b128 v[92:95], v172 offset:7168
    s_mov_b64 exec, s[40:41]
    ds_read_b128 v[210:213], v173 offset:6144
    ds_read_b128 v[214:217], v173 offset:6656
    s_mov_b64 exec, -1
    s_add_u32 m0, s56, 40960
    s_add_u32 s45, s57, 40960
    buffer_load_dwordx4 v174, s[8:11], s45 offen sc1 lds
    s_add_u32 m0, s56, 106496
    s_add_u32 s45, s57, 4235264
    buffer_load_dwordx4 v174, s[8:11], s45 offen sc1 lds
    v_exp_f32 v70, v70
    v_exp_f32 v71, v71
    v_cvt_pk_bf16_f32 v82, v68, v69
    v_exp_f32 v72, v72
    v_exp_f32 v73, v73
    v_cvt_pk_bf16_f32 v83, v70, v71
    v_exp_f32 v74, v74
    v_exp_f32 v75, v75
    s_waitcnt lgkmcnt(3)
    v_mfma_f32_32x32x16_bf16 v[16:31], v[218:221], v[80:83], v[16:31]
    v_exp_f32 v76, v76
    v_cvt_pk_bf16_f32 v84, v72, v73
    v_exp_f32 v77, v77
    v_exp_f32 v78, v78
    v_cvt_pk_bf16_f32 v85, v74, v75
    v_exp_f32 v79, v79
    v_cvt_pk_bf16_f32 v86, v76, v77
    v_cvt_pk_bf16_f32 v87, v78, v79
B_step6:
    s_waitcnt lgkmcnt(2)
    v_mfma_f32_32x32x16_bf16 v[64:79], v[92:95], v[12:15], 0
    v_exp_f32 v48, v48
    v_exp_f32 v49, v49
    v_exp_f32 v50, v50
    v_exp_f32 v51, v51
    v_cvt_pk_bf16_f32 v80, v48, v49
    v_exp_f32 v52, v52
    v_exp_f32 v53, v53
    v_cvt_pk_bf16_f32 v81, v50, v51
    v_mfma_f32_32x32x16_bf16 v[16:31], v[222:225], v[84:87], v[16:31]
    ds_read_b128 v[88:91], v172 offset:8192
    s_mov_b64 exec, s[40:41]
    ds_read_b128 v[218:221], v173 offset:7168
    ds_read_b128 v[222:225], v173 offset:7680
    s_mov_b64 exec, -1
    s_add_u32 m0, s56, 49152
    s_add_u32 s45, s57, 49152
    buffer_load_dwordx4 v174, s[8:11], s45 offen sc1 lds
    s_add_u32 m0, s56, 114688
    s_add_u32 s45, s57, 4243456
    buffer_load_dwordx4 v174, s[8:11], s45 offen sc1 lds
    v_exp_f32 v54, v54
    v_exp_f32 v55, v55
    v_cvt_pk_bf16_f32 v82, v52, v53
    v_exp_f32 v56, v56
    v_exp_f32 v57, v57
    v_cvt_pk_bf16_f32 v83, v54, v55
    v_exp_f32 v58, v58
    v_exp_f32 v59, v59
    s_waitcnt lgkmcnt(3)
    v_mfma_f32_32x32x16_bf16 v[16:31], v[210:213], v[80:83], v[16:31]
    v_exp_f32 v60, v60
    v_cvt_pk_bf16_f32 v84, v56, v57
    v_exp_f32 v61, v61
    v_exp_f32 v62, v62
    v_cvt_pk_bf16_f32 v85, v58, v59
    v_exp_f32 v63, v63
    v_cvt_pk_bf16_f32 v86, v60, v61
    v_cvt_pk_bf16_f32 v87, v62, v63
B_step7:
    s_setprio 0
    s_waitcnt lgkmcnt(2)
    v_mfma_f32_32x32x16_bf16 v[48:63], v[88:91], v[12:15], v[156:171]
    v_exp_f32 v64, v64
    v_exp_f32 v65, v65
    v_exp_f32 v66, v66
    v_exp_f32 v67, v67
    v_cvt_pk_bf16_f32 v80, v64, v65
    v_exp_f32 v68, v68
    v_exp_f32 v69, v69
    v_cvt_pk_bf16_f32 v81, v66, v67
    v_mfma_f32_32x32x16_bf16 v[16:31], v[214:217], v[84:87], v[16:31]
    s_mov_b64 exec, s[40:41]
    ds_read_b128 v[210:213], v173 offset:8192
    ds_read_b128 v[214:217], v173 offset:8704
    s_mov_b64 exec, -1
    s_add_u32 m0, s56, 57344
    s_add_u32 s45, s57, 57344
    buffer_load_dwordx4 v174, s[8:11], s45 offen sc1 lds
    s_add_u32 m0, s56, 122880
    s_add_u32 s45, s57, 4251648
    buffer_load_dwordx4 v174, s[8:11], s45 offen sc1 lds
    v_exp_f32 v70, v70
    v_exp_f32 v71, v71
    v_cvt_pk_bf16_f32 v82, v68, v69
    v_exp_f32 v72, v72
    v_exp_f32 v73, v73
    v_cvt_pk_bf16_f32 v83, v70, v71
    v_exp_f32 v74, v74
    v_exp_f32 v75, v75
    s_waitcnt lgkmcnt(2)
    v_mfma_f32_32x32x16_bf16 v[16:31], v[218:221], v[80:83], v[16:31]
    v_exp_f32 v76, v76
    v_cvt_pk_bf16_f32 v84, v72, v73
    v_exp_f32 v77, v77
    v_exp_f32 v78, v78
    v_cvt_pk_bf16_f32 v85, v74, v75
    v_exp_f32 v79, v79
    v_cvt_pk_bf16_f32 v86, v76, v77
    v_cvt_pk_bf16_f32 v87, v78, v79
B_step8:
    v_exp_f32 v48, v48
    v_exp_f32 v49, v49
    v_exp_f32 v50, v50
    v_exp_f32 v51, v51
    v_cvt_pk_bf16_f32 v80, v48, v49
    v_exp_f32 v52, v52
    v_exp_f32 v53, v53
    v_cvt_pk_bf16_f32 v81, v50, v51
    v_mfma_f32_32x32x16_bf16 v[16:31], v[222:225], v[84:87], v[16:31]
    v_exp_f32 v54, v54
    v_exp_f32 v55, v55
    v_cvt_pk_bf16_f32 v82, v52, v53
    v_exp_f32 v56, v56
    v_exp_f32 v57, v57
    v_cvt_pk_bf16_f32 v83, v54, v55
    v_exp_f32 v58, v58
    v_exp_f32 v59, v59
    s_waitcnt lgkmcnt(0)
    v_mfma_f32_32x32x16_bf16 v[16:31], v[210:213], v[80:83], v[16:31]
    v_exp_f32 v60, v60
    v_cvt_pk_bf16_f32 v84, v56, v57
    v_exp_f32 v61, v61
    v_exp_f32 v62, v62
    v_cvt_pk_bf16_f32 v85, v58, v59
    v_exp_f32 v63, v63
    v_cvt_pk_bf16_f32 v86, v60, v61
    v_cvt_pk_bf16_f32 v87, v62, v63
    s_nop 1
    v_mfma_f32_32x32x16_bf16 v[16:31], v[214:217], v[84:87], v[16:31]
    s_nop 7
    s_nop 3
    v_mov_b32 v175, v24
    s_nop 1
    v_permlane32_swap_b32 v175, v24
    s_nop 1
    v_add_f32 v24, v24, v175
    v_mov_b32 v175, v24
    v_fma_f32 v175, v16, 0, v175
    v_fma_f32 v175, v17, 0, v175
    v_fma_f32 v175, v18, 0, v175
    v_fma_f32 v175, v19, 0, v175
    v_fma_f32 v175, v20, 0, v175
    v_fma_f32 v175, v21, 0, v175
    v_fma_f32 v175, v22, 0, v175
    v_fma_f32 v175, v23, 0, v175
    s_mov_b32 s44, 0x1f800000
    s_mov_b32 s45, 0x5f800000
    v_cmp_le_f32 s[46:47], s44, v175
    v_cmp_ge_f32 s[48:49], s45, v175
    s_nop 1
    s_and_b64 s[46:47], s[46:47], s[48:49]
    s_cmp_eq_u64 s[46:47], -1
    s_cbranch_scc0 B_slow
B_ok:
    v_rcp_f32 v175, v24
    s_nop 0
    v_mul_f32 v16, v16, v175
    v_mul_f32 v17, v17, v175
    v_mul_f32 v18, v18, v175
    v_mul_f32 v19, v19, v175
    v_mul_f32 v20, v20, v175
    v_mul_f32 v21, v21, v175
    v_mul_f32 v22, v22, v175
    v_mul_f32 v23, v23, v175
    v_cvt_pk_bf16_f32 v184, v16, v17
    v_cvt_pk_bf16_f32 v185, v18, v19
    v_cvt_pk_bf16_f32 v186, v20, v21
    v_cvt_pk_bf16_f32 v187, v22, v23
    buffer_store_dwordx4 v[184:187], v174, s[8:11], s33 offen sc1
    s_waitcnt vmcnt(1)
    s_barrier
    s_mov_b64 exec, 1
    buffer_store_dword v250, v251, s[8:11], s62 offen sc1
    s_mov_b64 exec, -1
    s_lshl_b32 s43, s16, 15
    v_add_u32 v172, s43, v174
    s_add_u32 s44, s43, 65536
    v_add_u32 v173, s44, v188
    v_mov_b32 v16, 0
    v_mov_b32 v17, 0
    v_mov_b32 v18, 0
    v_mov_b32 v19, 0
    v_mov_b32 v20, 0
    v_mov_b32 v21, 0
    v_mov_b32 v22, 0
    v_mov_b32 v23, 0
    v_mov_b32 v24, 0
    v_mov_b32 v25, 0
    v_mov_b32 v26, 0
    v_mov_b32 v27, 0
    v_mov_b32 v28, 0
    v_mov_b32 v29, 0
    v_mov_b32 v30, 0
    v_mov_b32 v31, 0
    v_mov_b32 v32, 0
    v_mov_b32 v33, 0
    v_mov_b32 v34, 0
    v_mov_b32 v35, 0
    v_mov_b32 v36, 0
    v_mov_b32 v37, 0
    v_mov_b32 v38, 0
    v_mov_b32 v39, 0
    v_mov_b32 v40, 0
    v_mov_b32 v41, 0
    v_mov_b32 v42, 0
    v_mov_b32 v43, 0
    v_mov_b32 v44, 0
    v_mov_b32 v45, 0
    v_mov_b32 v46, 0
    v_mov_b32 v47, 0
    v_mov_b32 v84, 0
    v_mov_b32 v85, 0
    v_mov_b32 v86, 0
    v_mov_b32 v87, 0
    ds_read_b128 v[88:91], v172 offset:0
    s_mov_b64 exec, s[40:41]
    ds_read_b128 v[210:213], v173 offset:0
    ds_read_b128 v[214:217], v173 offset:512
    s_mov_b64 exec, -1
    s_waitcnt lgkmcnt(2)
    v_mfma_f32_32x32x16_bf16 v[48:63], v[88:91], v[4:7], 0
    s_mov_b32 s12, s86
    s_mov_b32 s13, s87
    s_mov_b32 s14, 524288
    s_mov_b32 s15, 0x00020000
    v_lshrrev_b32 v190, 2, v1
    v_lshlrev_b32 v190, 10, v190
    v_and_b32 v175, 3, v1
    v_lshl_add_u32 v190, v175, 4, v190
    s_lshr_b32 s42, s26, 2
    s_lshl_b32 s42, s42, 7
    s_bfe_u32 s43, s24, 0x10001
    s_lshl_b32 s43, s43, 6
    s_add_u32 s42, s42, s43
    v_add_u32 v190, s42, v190
    s_lshr_b32 s82, s24, 2
    s_lshl_b32 s82, s82, 18
    s_lshl_b32 s83, s24, 12
    s_add_u32 s83, s83, 131072
    v_lshrrev_b32 v175, 5, v1
    v_bfe_u32 v191, v1, 2, 2
    v_lshl_add_u32 v191, v175, 2, v191
    v_lshlrev_b32 v191, 6, v191
    v_bfe_u32 v175, v1, 4, 1
    v_lshl_add_u32 v191, v175, 5, v191
    v_and_b32 v175, 3, v1
    v_lshl_add_u32 v191, v175, 3, v191
    v_add_u32 v191, s83, v191
    s_add_u32 m0, s83, 0
    s_add_u32 s45, s82, 0
    buffer_load_dwordx4 v190, s[12:15], s45 offen lds
    s_add_u32 m0, s83, 1024
    s_add_u32 s45, s82, 16384
    buffer_load_dwordx4 v190, s[12:15], s45 offen lds
    s_add_u32 m0, s83, 2048
    s_add_u32 s45, s82, 32768
    buffer_load_dwordx4 v190, s[12:15], s45 offen lds
    s_add_u32 m0, s83, 3072
    s_add_u32 s45, s82, 49152
    buffer_load_dwordx4 v190, s[12:15], s45 offen lds
    s_add_u32 s82, s82, 65536
    s_lshl_b32 s34, s27, 10
    s_lshl_b32 s35, s31, 5
    s_add_u32 s34, s34, s35
    s_lshl_b32 s35, s24, 2
    s_add_u32 s34, s34, s35
    s_add_u32 s35, s34, 31490048
    s_add_u32 s34, s34, 31473664
    v_mov_b32 v112, s3
    v_mov_b32 v113, 0
    v_lshrrev_b32 v114, 1, v1
    v_lshlrev_b32 v114, 5, v114
    v_and_b32 v175, 1, v1
    v_lshl_add_u32 v114, v175, 4, v114
    s_and_b32 s36, s26, 3
    s_lshl_b32 s36, s36, 2
    v_add_u32 v114, s36, v114
    s_lshl_b32 s36, s25, 10
    s_add_u32 s36, s36, 31473664
    s_mov_b32 s53, 4
    s_setprio 3
    s_nop 7
    s_nop 1
.p2align 3
A_loop:
    s_cmp_eq_u32 s53, 3
    s_cbranch_scc1 A_it1
    s_cmp_eq_u32 s53, 2
    s_cbranch_scc1 A_it2
    s_cmp_eq_u32 s53, 1
    s_cbranch_scc1 A_it3
A_body:
    v_mfma_f32_32x32x16_bf16 v[64:79], v[88:91], v[8:11], 0
    v_exp_f32 v48, v48
    v_exp_f32 v49, v49
    v_exp_f32 v50, v50
    v_exp_f32 v51, v51
    v_cvt_pk_bf16_f32 v80, v48, v49
    v_exp_f32 v52, v52
    v_exp_f32 v53, v53
    v_cvt_pk_bf16_f32 v81, v50, v51
    v_mfma_f32_32x32x16_bf16 v[32:47], v[222:225], v[84:87], v[32:47]
    ds_read_b128 v[92:95], v172 offset:1024
    s_mov_b64 exec, s[40:41]
    ds_read_b128 v[218:221], v173 offset:1024
    ds_read_b128 v[222:225], v173 offset:1536
    s_mov_b64 exec, -1
    v_exp_f32 v54, v54
    v_exp_f32 v55, v55
    v_cvt_pk_bf16_f32 v82, v52, v53
    v_exp_f32 v56, v56
    v_exp_f32 v57, v57
    v_cvt_pk_bf16_f32 v83, v54, v55
    v_exp_f32 v58, v58
    v_exp_f32 v59, v59
    s_waitcnt lgkmcnt(3)
    v_mfma_f32_32x32x16_bf16 v[16:31], v[210:213], v[80:83], v[16:31]
    v_exp_f32 v60, v60
    v_cvt_pk_bf16_f32 v84, v56, v57
    v_exp_f32 v61, v61
    v_exp_f32 v62, v62
    v_cvt_pk_bf16_f32 v85, v58, v59
    v_exp_f32 v63, v63
    v_cvt_pk_bf16_f32 v86, v60, v61
    v_cvt_pk_bf16_f32 v87, v62, v63
    s_waitcnt lgkmcnt(2)
    v_mfma_f32_32x32x16_bf16 v[48:63], v[92:95], v[4:7], 0
    v_exp_f32 v64, v64
    v_exp_f32 v65, v65
    v_exp_f32 v66, v66
    v_exp_f32 v67, v67
    v_cvt_pk_bf16_f32 v80, v64, v65
    v_exp_f32 v68, v68
    v_exp_f32 v69, v69
    v_cvt_pk_bf16_f32 v81, v66, v67
    v_mfma_f32_32x32x16_bf16 v[16:31], v[214:217], v[84:87], v[16:31]
    v_exp_f32 v70, v70
    v_exp_f32 v71, v71
    v_cvt_pk_bf16_f32 v82, v68, v69
    v_exp_f32 v72, v72
    v_exp_f32 v73, v73
    v_cvt_pk_bf16_f32 v83, v70, v71
    v_exp_f32 v74, v74
    v_exp_f32 v75, v75
    v_mfma_f32_32x32x16_bf16 v[32:47], v[210:213], v[80:83], v[32:47]
    v_exp_f32 v76, v76
    v_cvt_pk_bf16_f32 v84, v72, v73
    v_exp_f32 v77, v77
    v_exp_f32 v78, v78
    v_cvt_pk_bf16_f32 v85, v74, v75
    v_exp_f32 v79, v79
    v_cvt_pk_bf16_f32 v86, v76, v77
    v_cvt_pk_bf16_f32 v87, v78, v79
    v_mfma_f32_32x32x16_bf16 v[64:79], v[92:95], v[8:11], 0
    v_exp_f32 v48, v48
    v_exp_f32 v49, v49
    v_exp_f32 v50, v50
    v_exp_f32 v51, v51
    v_cvt_pk_bf16_f32 v80, v48, v49
    v_exp_f32 v52, v52
    v_exp_f32 v53, v53
    v_cvt_pk_bf16_f32 v81, v50, v51
    v_mfma_f32_32x32x16_bf16 v[32:47], v[214:217], v[84:87], v[32:47]
    ds_read_b128 v[88:91], v172 offset:2048
    s_mov_b64 exec, s[40:41]
    ds_read_b128 v[210:213], v173 offset:2048
    ds_read_b128 v[214:217], v173 offset:2560
    s_mov_b64 exec, -1
    v_exp_f32 v54, v54
    v_exp_f32 v55, v55
    v_cvt_pk_bf16_f32 v82, v52, v53
    v_exp_f32 v56, v56
    v_exp_f32 v57, v57
    v_cvt_pk_bf16_f32 v83, v54, v55
    v_exp_f32 v58, v58
    v_exp_f32 v59, v59
    s_waitcnt lgkmcnt(3)
    v_mfma_f32_32x32x16_bf16 v[16:31], v[218:221], v[80:83], v[16:31]
    v_exp_f32 v60, v60
    v_cvt_pk_bf16_f32 v84, v56, v57
    v_exp_f32 v61, v61
    v_exp_f32 v62, v62
    v_cvt_pk_bf16_f32 v85, v58, v59
    v_exp_f32 v63, v63
    v_cvt_pk_bf16_f32 v86, v60, v61
    v_cvt_pk_bf16_f32 v87, v62, v63
    s_waitcnt lgkmcnt(2)
    v_mfma_f32_32x32x16_bf16 v[48:63], v[88:91], v[4:7], 0
    v_exp_f32 v64, v64
    v_exp_f32 v65, v65
    v_exp_f32 v66, v66
    v_exp_f32 v67, v67
    v_cvt_pk_bf16_f32 v80, v64, v65
    v_exp_f32 v68, v68
    v_exp_f32 v69, v69
    v_cvt_pk_bf16_f32 v81, v66, v67
    v_mfma_f32_32x32x16_bf16 v[16:31], v[222:225], v[84:87], v[16:31]
    v_exp_f32 v70, v70
    v_exp_f32 v71, v71
    v_cvt_pk_bf16_f32 v82, v68, v69
    v_exp_f32 v72, v72
    v_exp_f32 v73, v73
    v_cvt_pk_bf16_f32 v83, v70, v71
    v_exp_f32 v74, v74
    v_exp_f32 v75, v75
    v_mfma_f32_32x32x16_bf16 v[32:47], v[218:221], v[80:83], v[32:47]
    v_exp_f32 v76, v76
    v_cvt_pk_bf16_f32 v84, v72, v73
    v_exp_f32 v77, v77
    v_exp_f32 v78, v78
    v_cvt_pk_bf16_f32 v85, v74, v75
    v_exp_f32 v79, v79
    v_cvt_pk_bf16_f32 v86, v76, v77
    v_cvt_pk_bf16_f32 v87, v78, v79
    v_mfma_f32_32x32x16_bf16 v[64:79], v[88:91], v[8:11], 0
    v_exp_f32 v48, v48
    v_exp_f32 v49, v49
    v_exp_f32 v50, v50
    v_exp_f32 v51, v51
    v_cvt_pk_bf16_f32 v80, v48, v49
    v_exp_f32 v52, v52
    v_exp_f32 v53, v53
    v_cvt_pk_bf16_f32 v81, v50, v51
    v_mfma_f32_32x32x16_bf16 v[32:47], v[222:225], v[84:87], v[32:47]
    ds_read_b128 v[92:95], v172 offset:3072
    s_mov_b64 exec, s[40:41]
    ds_read_b128 v[218:221], v173 offset:3072
    ds_read_b128 v[222:225], v173 offset:3584
    s_mov_b64 exec, -1
    v_exp_f32 v54, v54
    v_exp_f32 v55, v55
    v_cvt_pk_bf16_f32 v82, v52, v53
    v_exp_f32 v56, v56
    v_exp_f32 v57, v57
    v_cvt_pk_bf16_f32 v83, v54, v55
    v_exp_f32 v58, v58
    v_exp_f32 v59, v59
    s_waitcnt lgkmcnt(3)
    v_mfma_f32_32x32x16_bf16 v[16:31], v[210:213], v[80:83], v[16:31]
    v_exp_f32 v60, v60
    v_cvt_pk_bf16_f32 v84, v56, v57
    v_exp_f32 v61, v61
    v_exp_f32 v62, v62
    v_cvt_pk_bf16_f32 v85, v58, v59
    v_exp_f32 v63, v63
    v_cvt_pk_bf16_f32 v86, v60, v61
    v_cvt_pk_bf16_f32 v87, v62, v63
    s_waitcnt lgkmcnt(2)
    v_mfma_f32_32x32x16_bf16 v[48:63], v[92:95], v[4:7], 0
    v_exp_f32 v64, v64
    v_exp_f32 v65, v65
    v_exp_f32 v66, v66
    v_exp_f32 v67, v67
    v_cvt_pk_bf16_f32 v80, v64, v65
    v_exp_f32 v68, v68
    v_exp_f32 v69, v69
    v_cvt_pk_bf16_f32 v81, v66, v67
    v_mfma_f32_32x32x16_bf16 v[16:31], v[214:217], v[84:87], v[16:31]
    v_exp_f32 v70, v70
    v_exp_f32 v71, v71
    v_cvt_pk_bf16_f32 v82, v68, v69
    v_exp_f32 v72, v72
    v_exp_f32 v73, v73
    v_cvt_pk_bf16_f32 v83, v70, v71
    v_exp_f32 v74, v74
    v_exp_f32 v75, v75
    v_mfma_f32_32x32x16_bf16 v[32:47], v[210:213], v[80:83], v[32:47]
    v_exp_f32 v76, v76
    v_cvt_pk_bf16_f32 v84, v72, v73
    v_exp_f32 v77, v77
    v_exp_f32 v78, v78
    v_cvt_pk_bf16_f32 v85, v74, v75
    v_exp_f32 v79, v79
    v_cvt_pk_bf16_f32 v86, v76, v77
    v_cvt_pk_bf16_f32 v87, v78, v79
    v_mfma_f32_32x32x16_bf16 v[64:79], v[92:95], v[8:11], 0
    v_exp_f32 v48, v48
    v_exp_f32 v49, v49
    v_exp_f32 v50, v50
    v_exp_f32 v51, v51
    v_cvt_pk_bf16_f32 v80, v48, v49
    v_exp_f32 v52, v52
    v_exp_f32 v53, v53
    v_cvt_pk_bf16_f32 v81, v50, v51
    v_mfma_f32_32x32x16_bf16 v[32:47], v[214:217], v[84:87], v[32:47]
    ds_read_b128 v[88:91], v172 offset:4096
    s_mov_b64 exec, s[40:41]
    ds_read_b128 v[210:213], v173 offset:4096
    ds_read_b128 v[214:217], v173 offset:4608
    s_mov_b64 exec, -1
    v_exp_f32 v54, v54
    v_exp_f32 v55, v55
    v_cvt_pk_bf16_f32 v82, v52, v53
    v_exp_f32 v56, v56
    v_exp_f32 v57, v57
    v_cvt_pk_bf16_f32 v83, v54, v55
    v_exp_f32 v58, v58
    v_exp_f32 v59, v59
    s_waitcnt lgkmcnt(3)
    v_mfma_f32_32x32x16_bf16 v[16:31], v[218:221], v[80:83], v[16:31]
    v_exp_f32 v60, v60
    v_cvt_pk_bf16_f32 v84, v56, v57
    v_exp_f32 v61, v61
    v_exp_f32 v62, v62
    v_cvt_pk_bf16_f32 v85, v58, v59
    v_exp_f32 v63, v63
    v_cvt_pk_bf16_f32 v86, v60, v61
    v_cvt_pk_bf16_f32 v87, v62, v63
    s_waitcnt lgkmcnt(2)
    v_mfma_f32_32x32x16_bf16 v[48:63], v[88:91], v[4:7], 0
    v_exp_f32 v64, v64
    v_exp_f32 v65, v65
    v_exp_f32 v66, v66
    v_exp_f32 v67, v67
    v_cvt_pk_bf16_f32 v80, v64, v65
    v_exp_f32 v68, v68
    v_exp_f32 v69, v69
    v_cvt_pk_bf16_f32 v81, v66, v67
    v_mfma_f32_32x32x16_bf16 v[16:31], v[222:225], v[84:87], v[16:31]
    v_exp_f32 v70, v70
    v_exp_f32 v71, v71
    v_cvt_pk_bf16_f32 v82, v68, v69
    v_exp_f32 v72, v72
    v_exp_f32 v73, v73
    v_cvt_pk_bf16_f32 v83, v70, v71
    v_exp_f32 v74, v74
    v_exp_f32 v75, v75
    v_mfma_f32_32x32x16_bf16 v[32:47], v[218:221], v[80:83], v[32:47]
    v_exp_f32 v76, v76
    v_cvt_pk_bf16_f32 v84, v72, v73
    v_exp_f32 v77, v77
    v_exp_f32 v78, v78
    v_cvt_pk_bf16_f32 v85, v74, v75
    v_exp_f32 v79, v79
    v_cvt_pk_bf16_f32 v86, v76, v77
    v_cvt_pk_bf16_f32 v87, v78, v79
    s_cmp_ge_u32 s53, 3
    s_cbranch_scc1 A_mid
A_midback:
    v_mfma_f32_32x32x16_bf16 v[64:79], v[88:91], v[8:11], 0
    v_exp_f32 v48, v48
    v_exp_f32 v49, v49
    v_exp_f32 v50, v50
    v_exp_f32 v51, v51
    v_cvt_pk_bf16_f32 v80, v48, v49
    v_exp_f32 v52, v52
    v_exp_f32 v53, v53
    v_cvt_pk_bf16_f32 v81, v50, v51
    v_mfma_f32_32x32x16_bf16 v[32:47], v[222:225], v[84:87], v[32:47]
    ds_read_b128 v[92:95], v172 offset:5120
    s_mov_b64 exec, s[40:41]
    ds_read_b128 v[218:221], v173 offset:5120
    ds_read_b128 v[222:225], v173 offset:5632
    s_mov_b64 exec, -1
    v_exp_f32 v54, v54
    v_exp_f32 v55, v55
    v_cvt_pk_bf16_f32 v82, v52, v53
    v_exp_f32 v56, v56
    v_exp_f32 v57, v57
    v_cvt_pk_bf16_f32 v83, v54, v55
    v_exp_f32 v58, v58
    v_exp_f32 v59, v59
    s_waitcnt lgkmcnt(3)
    v_mfma_f32_32x32x16_bf16 v[16:31], v[210:213], v[80:83], v[16:31]
    v_exp_f32 v60, v60
    v_cvt_pk_bf16_f32 v84, v56, v57
    v_exp_f32 v61, v61
    v_exp_f32 v62, v62
    v_cvt_pk_bf16_f32 v85, v58, v59
    v_exp_f32 v63, v63
    v_cvt_pk_bf16_f32 v86, v60, v61
    v_cvt_pk_bf16_f32 v87, v62, v63
    s_waitcnt lgkmcnt(2)
    v_mfma_f32_32x32x16_bf16 v[48:63], v[92:95], v[4:7], 0
    v_exp_f32 v64, v64
    v_exp_f32 v65, v65
    v_exp_f32 v66, v66
    v_exp_f32 v67, v67
    v_cvt_pk_bf16_f32 v80, v64, v65
    v_exp_f32 v68, v68
    v_exp_f32 v69, v69
    v_cvt_pk_bf16_f32 v81, v66, v67
    v_mfma_f32_32x32x16_bf16 v[16:31], v[214:217], v[84:87], v[16:31]
    v_exp_f32 v70, v70
    v_exp_f32 v71, v71
    v_cvt_pk_bf16_f32 v82, v68, v69
    v_exp_f32 v72, v72
    v_exp_f32 v73, v73
    v_cvt_pk_bf16_f32 v83, v70, v71
    v_exp_f32 v74, v74
    v_exp_f32 v75, v75
    v_mfma_f32_32x32x16_bf16 v[32:47], v[210:213], v[80:83], v[32:47]
    v_exp_f32 v76, v76
    v_cvt_pk_bf16_f32 v84, v72, v73
    v_exp_f32 v77, v77
    v_exp_f32 v78, v78
    v_cvt_pk_bf16_f32 v85, v74, v75
    v_exp_f32 v79, v79
    v_cvt_pk_bf16_f32 v86, v76, v77
    v_cvt_pk_bf16_f32 v87, v78, v79
    v_mfma_f32_32x32x16_bf16 v[64:79], v[92:95], v[8:11], 0
    v_exp_f32 v48, v48
    v_exp_f32 v49, v49
    v_exp_f32 v50, v50
    v_exp_f32 v51, v51
    v_cvt_pk_bf16_f32 v80, v48, v49
    v_exp_f32 v52, v52
    v_exp_f32 v53, v53
    v_cvt_pk_bf16_f32 v81, v50, v51
    v_mfma_f32_32x32x16_bf16 v[32:47], v[214:217], v[84:87], v[32:47]
    ds_read_b128 v[88:91], v172 offset:6144
    s_mov_b64 exec, s[40:41]
    ds_read_b128 v[210:213], v173 offset:6144
    ds_read_b128 v[214:217], v173 offset:6656
    s_mov_b64 exec, -1
    v_exp_f32 v54, v54
    v_exp_f32 v55, v55
    v_cvt_pk_bf16_f32 v82, v52, v53
    v_exp_f32 v56, v56
    v_exp_f32 v57, v57
    v_cvt_pk_bf16_f32 v83, v54, v55
    v_exp_f32 v58, v58
    v_exp_f32 v59, v59
    s_waitcnt lgkmcnt(3)
    v_mfma_f32_32x32x16_bf16 v[16:31], v[218:221], v[80:83], v[16:31]
    v_exp_f32 v60, v60
    v_cvt_pk_bf16_f32 v84, v56, v57
    v_exp_f32 v61, v61
    v_exp_f32 v62, v62
    v_cvt_pk_bf16_f32 v85, v58, v59
    v_exp_f32 v63, v63
    v_cvt_pk_bf16_f32 v86, v60, v61
    v_cvt_pk_bf16_f32 v87, v62, v63
    s_waitcnt lgkmcnt(2)
    v_mfma_f32_32x32x16_bf16 v[48:63], v[88:91], v[4:7], 0
    v_exp_f32 v64, v64
    v_exp_f32 v65, v65
    v_exp_f32 v66, v66
    v_exp_f32 v67, v67
    v_cvt_pk_bf16_f32 v80, v64, v65
    v_exp_f32 v68, v68
    v_exp_f32 v69, v69
    v_cvt_pk_bf16_f32 v81, v66, v67
    v_mfma_f32_32x32x16_bf16 v[16:31], v[222:225], v[84:87], v[16:31]
    v_exp_f32 v70, v70
    v_exp_f32 v71, v71
    v_cvt_pk_bf16_f32 v82, v68, v69
    v_exp_f32 v72, v72
    v_exp_f32 v73, v73
    v_cvt_pk_bf16_f32 v83, v70, v71
    v_exp_f32 v74, v74
    v_exp_f32 v75, v75
    v_mfma_f32_32x32x16_bf16 v[32:47], v[218:221], v[80:83], v[32:47]
    v_exp_f32 v76, v76
    v_cvt_pk_bf16_f32 v84, v72, v73
    v_exp_f32 v77, v77
    v_exp_f32 v78, v78
    v_cvt_pk_bf16_f32 v85, v74, v75
    v_exp_f32 v79, v79
    v_cvt_pk_bf16_f32 v86, v76, v77
    v_cvt_pk_bf16_f32 v87, v78, v79
    v_mfma_f32_32x32x16_bf16 v[64:79], v[88:91], v[8:11], 0
    v_exp_f32 v48, v48
    v_exp_f32 v49, v49
    v_exp_f32 v50, v50
    v_exp_f32 v51, v51
    v_cvt_pk_bf16_f32 v80, v48, v49
    v_exp_f32 v52, v52
    v_exp_f32 v53, v53
    v_cvt_pk_bf16_f32 v81, v50, v51
    v_mfma_f32_32x32x16_bf16 v[32:47], v[222:225], v[84:87], v[32:47]
    ds_read_b128 v[92:95], v172 offset:7168
    s_mov_b64 exec, s[40:41]
    ds_read_b128 v[218:221], v173 offset:7168
    ds_read_b128 v[222:225], v173 offset:7680
    s_mov_b64 exec, -1
    v_exp_f32 v54, v54
    v_exp_f32 v55, v55
    v_cvt_pk_bf16_f32 v82, v52, v53
    v_exp_f32 v56, v56
    v_exp_f32 v57, v57
    v_cvt_pk_bf16_f32 v83, v54, v55
    v_exp_f32 v58, v58
    v_exp_f32 v59, v59
    s_waitcnt lgkmcnt(3)
    v_mfma_f32_32x32x16_bf16 v[16:31], v[210:213], v[80:83], v[16:31]
    v_exp_f32 v60, v60
    v_cvt_pk_bf16_f32 v84, v56, v57
    v_exp_f32 v61, v61
    v_exp_f32 v62, v62
    v_cvt_pk_bf16_f32 v85, v58, v59
    v_exp_f32 v63, v63
    v_cvt_pk_bf16_f32 v86, v60, v61
    v_cvt_pk_bf16_f32 v87, v62, v63
    s_waitcnt lgkmcnt(2)
    v_mfma_f32_32x32x16_bf16 v[48:63], v[92:95], v[4:7], 0
    v_exp_f32 v64, v64
    v_exp_f32 v65, v65
    v_exp_f32 v66, v66
    v_exp_f32 v67, v67
    v_cvt_pk_bf16_f32 v80, v64, v65
    v_exp_f32 v68, v68
    v_exp_f32 v69, v69
    v_cvt_pk_bf16_f32 v81, v66, v67
    v_mfma_f32_32x32x16_bf16 v[16:31], v[214:217], v[84:87], v[16:31]
    v_exp_f32 v70, v70
    v_exp_f32 v71, v71
    v_cvt_pk_bf16_f32 v82, v68, v69
    v_exp_f32 v72, v72
    v_exp_f32 v73, v73
    v_cvt_pk_bf16_f32 v83, v70, v71
    v_exp_f32 v74, v74
    v_exp_f32 v75, v75
    v_mfma_f32_32x32x16_bf16 v[32:47], v[210:213], v[80:83], v[32:47]
    v_exp_f32 v76, v76
    v_cvt_pk_bf16_f32 v84, v72, v73
    v_exp_f32 v77, v77
    v_exp_f32 v78, v78
    v_cvt_pk_bf16_f32 v85, v74, v75
    v_exp_f32 v79, v79
    v_cvt_pk_bf16_f32 v86, v76, v77
    v_cvt_pk_bf16_f32 v87, v78, v79
    v_mfma_f32_32x32x16_bf16 v[64:79], v[92:95], v[8:11], 0
    v_exp_f32 v48, v48
    v_exp_f32 v49, v49
    v_exp_f32 v50, v50
    v_exp_f32 v51, v51
    v_cvt_pk_bf16_f32 v80, v48, v49
    v_exp_f32 v52, v52
    v_exp_f32 v53, v53
    v_cvt_pk_bf16_f32 v81, v50, v51
    v_mfma_f32_32x32x16_bf16 v[32:47], v[214:217], v[84:87], v[32:47]
    ds_read_b128 v[88:91], v172 offset:8192
    s_mov_b64 exec, s[40:41]
    ds_read_b128 v[210:213], v173 offset:8192
    ds_read_b128 v[214:217], v173 offset:8704
    s_mov_b64 exec, -1
    v_exp_f32 v54, v54
    v_exp_f32 v55, v55
    v_cvt_pk_bf16_f32 v82, v52, v53
    v_exp_f32 v56, v56
    v_exp_f32 v57, v57
    v_cvt_pk_bf16_f32 v83, v54, v55
    v_exp_f32 v58, v58
    v_exp_f32 v59, v59
    s_waitcnt lgkmcnt(3)
    v_mfma_f32_32x32x16_bf16 v[16:31], v[218:221], v[80:83], v[16:31]
    v_exp_f32 v60, v60
    v_cvt_pk_bf16_f32 v84, v56, v57
    v_exp_f32 v61, v61
    v_exp_f32 v62, v62
    v_cvt_pk_bf16_f32 v85, v58, v59
    v_exp_f32 v63, v63
    v_cvt_pk_bf16_f32 v86, v60, v61
    v_cvt_pk_bf16_f32 v87, v62, v63
    s_waitcnt lgkmcnt(2)
    v_mfma_f32_32x32x16_bf16 v[48:63], v[88:91], v[4:7], 0
    v_exp_f32 v64, v64
    v_exp_f32 v65, v65
    v_exp_f32 v66, v66
    v_exp_f32 v67, v67
    v_cvt_pk_bf16_f32 v80, v64, v65
    v_exp_f32 v68, v68
    v_exp_f32 v69, v69
    v_cvt_pk_bf16_f32 v81, v66, v67
    v_mfma_f32_32x32x16_bf16 v[16:31], v[222:225], v[84:87], v[16:31]
    v_exp_f32 v70, v70
    v_exp_f32 v71, v71
    v_cvt_pk_bf16_f32 v82, v68, v69
    v_exp_f32 v72, v72
    v_exp_f32 v73, v73
    v_cvt_pk_bf16_f32 v83, v70, v71
    v_exp_f32 v74, v74
    v_exp_f32 v75, v75
    v_mfma_f32_32x32x16_bf16 v[32:47], v[218:221], v[80:83], v[32:47]
    v_exp_f32 v76, v76
    v_cvt_pk_bf16_f32 v84, v72, v73
    v_exp_f32 v77, v77
    v_exp_f32 v78, v78
    v_cvt_pk_bf16_f32 v85, v74, v75
    v_exp_f32 v79, v79
    v_cvt_pk_bf16_f32 v86, v76, v77
    v_cvt_pk_bf16_f32 v87, v78, v79
    v_add_u32 v172, 8192, v172
    v_add_u32 v173, 8192, v173
    s_sub_u32 s53, s53, 1
    s_cmp_lg_u32 s53, 0
    s_cbranch_scc1 A_loop
A_after:
    v_mfma_f32_32x32x16_bf16 v[32:47], v[222:225], v[84:87], v[32:47]
    s_waitcnt lgkmcnt(0)
    s_nop 7
    s_nop 3
    s_lshl_b32 s43, s24, 12
    s_add_u32 s43, s43, 131072
    v_add_u32 v175, s43, v174
    v_lshlrev_b32 v176, 2, v1
    v_add_u32 v176, s43, v176
    ds_write_b128 v175, v[32:35]
    ds_write_b128 v175, v[36:39] offset:1024
    ds_write_b32 v176, v40 offset:2048
    s_xor_b32 s44, s24, 4
    s_lshl_b32 s43, s44, 12
    s_add_u32 s43, s43, 131072
    v_add_u32 v175, s43, v174
    v_lshlrev_b32 v176, 2, v1
    v_add_u32 v176, s43, v176
    s_waitcnt lgkmcnt(0)
    s_barrier
    ds_read_b128 v[48:51], v175
    ds_read_b128 v[52:55], v175 offset:1024
    ds_read_b32 v56, v176 offset:2048
    s_waitcnt lgkmcnt(0)
    v_add_f32 v16, v16, v48
    v_add_f32 v17, v17, v49
    v_add_f32 v18, v18, v50
    v_add_f32 v19, v19, v51
    v_add_f32 v20, v20, v52
    v_add_f32 v21, v21, v53
    v_add_f32 v22, v22, v54
    v_add_f32 v23, v23, v55
    v_add_f32 v24, v24, v56
    v_mov_b32 v175, v24
    s_nop 1
    v_permlane32_swap_b32 v175, v24
    s_nop 1
    v_add_f32 v24, v24, v175
    v_mov_b32 v175, v24
    v_fma_f32 v175, v16, 0, v175
    v_fma_f32 v175, v17, 0, v175
    v_fma_f32 v175, v18, 0, v175
    v_fma_f32 v175, v19, 0, v175
    v_fma_f32 v175, v20, 0, v175
    v_fma_f32 v175, v21, 0, v175
    v_fma_f32 v175, v22, 0, v175
    v_fma_f32 v175, v23, 0, v175
    s_mov_b32 s44, 0x1f800000
    s_mov_b32 s45, 0x5f800000
    v_cmp_le_f32 s[46:47], s44, v175
    v_cmp_ge_f32 s[48:49], s45, v175
    s_nop 1
    s_and_b64 s[46:47], s[46:47], s[48:49]
    s_cmp_eq_u64 s[46:47], -1
    s_cbranch_scc0 A_slow
A_ok:
    v_rcp_f32 v175, v24
    s_nop 0
    v_mul_f32 v16, v16, v175
    v_mul_f32 v17, v17, v175
    v_mul_f32 v18, v18, v175
    v_mul_f32 v19, v19, v175
    v_mul_f32 v20, v20, v175
    v_mul_f32 v21, v21, v175
    v_mul_f32 v22, v22, v175
    v_mul_f32 v23, v23, v175
    v_cvt_pk_bf16_f32 v184, v16, v17
    v_cvt_pk_bf16_f32 v185, v18, v19
    v_cvt_pk_bf16_f32 v186, v20, v21
    v_cvt_pk_bf16_f32 v187, v22, v23
    buffer_store_dwordx4 v[184:187], v174, s[8:11], s32 offen sc1
    s_mov_b32 s12, s84
    s_mov_b32 s13, s85
    s_mov_b32 s14, 524288
    s_mov_b32 s15, 0x00020000
    s_mov_b32 s20, s88
    s_mov_b32 s21, s89
    s_mov_b32 s22, 2097152
    s_mov_b32 s23, 0x00020000
    s_and_b32 s50, s26, 3
    s_lshr_b32 s51, s26, 2
    s_and_b32 s52, s24, 1
    s_bfe_u32 s53, s24, 0x10001
    s_lshr_b32 s54, s24, 2
    v_lshlrev_b32 v3, 4, v1
    s_lshl_b32 s42, s25, 3
    s_lshl_b32 s43, s50, 1
    s_add_u32 s42, s42, s43
    s_lshl_b32 s55, s42, 16
    s_add_u32 s55, s55, 16777216
    s_lshl_b32 s43, s53, 14
    s_lshl_b32 s44, s54, 12
    s_add_u32 s43, s43, s44
    s_lshl_b32 s56, s52, 15
    s_add_u32 s56, s56, s43
    s_add_u32 s56, s56, 0x10000
    s_lshl_b32 s57, s52, 16
    s_add_u32 s57, s57, s43
    s_add_u32 s57, s57, s55
    s_waitcnt vmcnt(1)
    s_mov_b32 s46, 1048576
P3_bchk:
    v_cmp_ne_u32 vcc, s3, v115
    s_nop 1
    s_cmp_eq_u64 vcc, 0
    s_cbranch_scc1 P3_bok
    s_sub_u32 s46, s46, 1
    s_cmp_eq_u32 s46, 0
    s_cbranch_scc1 P3_bok
    s_sleep 1
    buffer_load_dword v115, v114, s[8:11], s36 offen sc1
    s_waitcnt vmcnt(0)
    s_branch P3_bchk
P3_bok:
    s_barrier
    s_add_u32 m0, s56, 0
    s_add_u32 s45, s57, 32768
    buffer_load_dwordx4 v3, s[8:11], s45 offen sc1 lds
    s_add_u32 m0, s56, 1024
    s_add_u32 s45, s57, 33792
    buffer_load_dwordx4 v3, s[8:11], s45 offen sc1 lds
    s_add_u32 m0, s56, 2048
    s_add_u32 s45, s57, 34816
    buffer_load_dwordx4 v3, s[8:11], s45 offen sc1 lds
    s_add_u32 m0, s56, 3072
    s_add_u32 s45, s57, 35840
    buffer_load_dwordx4 v3, s[8:11], s45 offen sc1 lds
    s_add_u32 m0, s56, 8192
    s_add_u32 s45, s57, 40960
    buffer_load_dwordx4 v3, s[8:11], s45 offen sc1 lds
    s_add_u32 m0, s56, 9216
    s_add_u32 s45, s57, 41984
    buffer_load_dwordx4 v3, s[8:11], s45 offen sc1 lds
    s_add_u32 m0, s56, 10240
    s_add_u32 s45, s57, 43008
    buffer_load_dwordx4 v3, s[8:11], s45 offen sc1 lds
    s_add_u32 m0, s56, 11264
    s_add_u32 s45, s57, 44032
    buffer_load_dwordx4 v3, s[8:11], s45 offen sc1 lds
    s_waitcnt vmcnt(8)
    s_mov_b64 exec, 1
    buffer_store_dword v112, v113, s[8:11], s35 offen sc1
    s_mov_b64 exec, -1
    v_and_b32 v12, 31, v1
    s_lshl_b32 s44, s25, 8
    s_lshl_b32 s45, s50, 6
    s_add_u32 s44, s44, s45
    s_lshl_b32 s45, s52, 5
    s_add_u32 s44, s44, s45
    v_add_u32 v12, s44, v12
    v_lshlrev_b32 v13, 2, v12
    s_mov_b32 s45, 12582912
    buffer_load_dword v14, v13, s[8:11], s45 offen sc1
    v_lshrrev_b32 v5, 3, v1
    v_lshlrev_b32 v5, 10, v5
    v_bfe_u32 v6, v1, 4, 1
    v_lshlrev_b32 v6, 2, v6
    v_and_b32 v7, 7, v1
    v_xor_b32 v6, v6, v7
    v_lshl_add_u32 v5, v6, 4, v5
    s_lshl_b32 s42, s51, 7
    v_add_u32 v4, s42, v5
    s_lshl_b32 s58, s24, 13
    s_lshl_b32 s59, s24, 16
    s_add_u32 m0, s58, 0
    s_add_u32 s45, s59, 0
    buffer_load_dwordx4 v4, s[12:15], s45 offen lds
    s_add_u32 m0, s58, 1024
    s_add_u32 s45, s59, 8192
    buffer_load_dwordx4 v4, s[12:15], s45 offen lds
    s_add_u32 m0, s58, 2048
    s_add_u32 s45, s59, 16384
    buffer_load_dwordx4 v4, s[12:15], s45 offen lds
    s_add_u32 m0, s58, 3072
    s_add_u32 s45, s59, 24576
    buffer_load_dwordx4 v4, s[12:15], s45 offen lds
    s_add_u32 m0, s58, 4096
    s_add_u32 s45, s59, 32768
    buffer_load_dwordx4 v4, s[12:15], s45 offen lds
    s_add_u32 m0, s58, 5120
    s_add_u32 s45, s59, 40960
    buffer_load_dwordx4 v4, s[12:15], s45 offen lds
    s_add_u32 m0, s58, 6144
    s_add_u32 s45, s59, 49152
    buffer_load_dwordx4 v4, s[12:15], s45 offen lds
    s_add_u32 m0, s58, 7168
    s_add_u32 s45, s59, 57344
    buffer_load_dwordx4 v4, s[12:15], s45 offen lds
    v_lshrrev_b32 v6, 5, v1
    v_bfe_u32 v9, v1, 2, 2
    v_lshl_add_u32 v9, v6, 2, v9
    v_lshlrev_b32 v9, 7, v9
    v_bfe_u32 v6, v1, 4, 1
    v_lshlrev_b32 v6, 1, v6
    v_bfe_u32 v7, v1, 1, 1
    v_add_u32 v6, v6, v7
    s_lshl_b32 s42, s53, 2
    v_add_u32 v6, s42, v6
    v_bfe_u32 v7, v1, 3, 1
    v_lshlrev_b32 v7, 2, v7
    v_xor_b32 v6, v6, v7
    v_lshl_add_u32 v9, v6, 4, v9
    v_and_b32 v7, 1, v1
    v_lshl_add_u32 v9, v7, 3, v9
    v_lshrrev_b32 v8, 5, v1
    s_lshl_b32 s42, s54, 15
    v_add_u32 v9, s42, v9
    s_lshl_b32 s43, s52, 15
    s_lshl_b32 s44, s54, 14
    s_add_u32 s43, s43, s44
    s_add_u32 s43, s43, 0x10000
    v_add_u32 v11, s43, v3
    v_mov_b32 v48, 0
    v_mov_b32 v16, 0
    v_mov_b32 v49, 0
    v_mov_b32 v17, 0
    v_mov_b32 v50, 0
    v_mov_b32 v18, 0
    v_mov_b32 v51, 0
    v_mov_b32 v19, 0
    v_mov_b32 v52, 0
    v_mov_b32 v20, 0
    v_mov_b32 v53, 0
    v_mov_b32 v21, 0
    v_mov_b32 v54, 0
    v_mov_b32 v22, 0
    v_mov_b32 v55, 0
    v_mov_b32 v23, 0
    v_mov_b32 v56, 0
    v_mov_b32 v24, 0
    v_mov_b32 v57, 0
    v_mov_b32 v25, 0
    v_mov_b32 v58, 0
    v_mov_b32 v26, 0
    v_mov_b32 v59, 0
    v_mov_b32 v27, 0
    v_mov_b32 v60, 0
    v_mov_b32 v28, 0
    v_mov_b32 v61, 0
    v_mov_b32 v29, 0
    v_mov_b32 v62, 0
    v_mov_b32 v30, 0
    v_mov_b32 v63, 0
    v_mov_b32 v31, 0
    s_waitcnt vmcnt(10)
    s_barrier
    ds_read_b128 v[64:67], v11 offset:0
    ds_read_b128 v[68:71], v11 offset:1024
    ds_read_b128 v[72:75], v11 offset:2048
    ds_read_b128 v[76:79], v11 offset:3072
    s_waitcnt lgkmcnt(3)
    v_mfma_f32_32x32x16_bf16 v[48:63], v[96:99], v[64:67], v[48:63]
    ds_read_b128 v[64:67], v11 offset:4096
    s_waitcnt lgkmcnt(3)
    v_mfma_f32_32x32x16_bf16 v[48:63], v[100:103], v[68:71], v[48:63]
    ds_read_b128 v[68:71], v11 offset:5120
    s_waitcnt lgkmcnt(3)
    v_mfma_f32_32x32x16_bf16 v[48:63], v[104:107], v[72:75], v[48:63]
    ds_read_b128 v[72:75], v11 offset:6144
    s_waitcnt lgkmcnt(3)
    v_mfma_f32_32x32x16_bf16 v[48:63], v[108:111], v[76:79], v[48:63]
    ds_read_b128 v[76:79], v11 offset:7168
    s_waitcnt lgkmcnt(3)
    v_mfma_f32_32x32x16_bf16 v[48:63], v[120:123], v[64:67], v[48:63]
    ds_read_b128 v[64:67], v11 offset:8192
    s_waitcnt lgkmcnt(3)
    v_mfma_f32_32x32x16_bf16 v[48:63], v[124:127], v[68:71], v[48:63]
    ds_read_b128 v[68:71], v11 offset:9216
    s_waitcnt lgkmcnt(3)
    v_mfma_f32_32x32x16_bf16 v[48:63], v[128:131], v[72:75], v[48:63]
    ds_read_b128 v[72:75], v11 offset:10240
    s_waitcnt lgkmcnt(3)
    v_mfma_f32_32x32x16_bf16 v[48:63], v[132:135], v[76:79], v[48:63]
    ds_read_b128 v[76:79], v11 offset:11264
    s_waitcnt lgkmcnt(3)
    v_mfma_f32_32x32x16_bf16 v[48:63], v[136:139], v[64:67], v[48:63]
    ds_read_b128 v[64:67], v11 offset:12288
    s_waitcnt lgkmcnt(3)
    v_mfma_f32_32x32x16_bf16 v[48:63], v[192:195], v[68:71], v[48:63]
    ds_read_b128 v[68:71], v11 offset:13312
    s_waitcnt lgkmcnt(3)
    v_mfma_f32_32x32x16_bf16 v[48:63], v[196:199], v[72:75], v[48:63]
    ds_read_b128 v[72:75], v11 offset:14336
    s_waitcnt lgkmcnt(3)
    v_mfma_f32_32x32x16_bf16 v[48:63], v[200:203], v[76:79], v[48:63]
    ds_read_b128 v[76:79], v11 offset:15360
    s_waitcnt lgkmcnt(3)
    v_mfma_f32_32x32x16_bf16 v[48:63], v[204:207], v[64:67], v[48:63]
    s_waitcnt lgkmcnt(2)
    v_mfma_f32_32x32x16_bf16 v[48:63], v[228:231], v[68:71], v[48:63]
    s_waitcnt lgkmcnt(1)
    v_mfma_f32_32x32x16_bf16 v[48:63], v[232:235], v[72:75], v[48:63]
    s_waitcnt lgkmcnt(0)
    v_mfma_f32_32x32x16_bf16 v[48:63], v[236:239], v[76:79], v[48:63]
    s_add_u32 s36, s36, 16384
    s_cmp_lg_u32 s24, 0
    s_cbranch_scc1 P3_askip
    s_mov_b32 s46, 1048576
P3_achk:
    buffer_load_dword v115, v114, s[8:11], s36 offen sc1
    s_waitcnt vmcnt(0)
    v_cmp_ne_u32 vcc, s3, v115
    s_nop 1
    s_cmp_eq_u64 vcc, 0
    s_cbranch_scc1 P3_askip
    s_sub_u32 s46, s46, 1
    s_cmp_eq_u32 s46, 0
    s_cbranch_scc1 P3_askip
    s_branch P3_achk
P3_askip:
    s_waitcnt vmcnt(0)
    s_barrier
    s_add_u32 m0, s56, 0
    s_add_u32 s45, s57, 0
    buffer_load_dwordx4 v3, s[8:11], s45 offen sc1 lds
    s_add_u32 m0, s56, 1024
    s_add_u32 s45, s57, 1024
    buffer_load_dwordx4 v3, s[8:11], s45 offen sc1 lds
    s_add_u32 m0, s56, 2048
    s_add_u32 s45, s57, 2048
    buffer_load_dwordx4 v3, s[8:11], s45 offen sc1 lds
    s_add_u32 m0, s56, 3072
    s_add_u32 s45, s57, 3072
    buffer_load_dwordx4 v3, s[8:11], s45 offen sc1 lds
    s_add_u32 m0, s56, 8192
    s_add_u32 s45, s57, 8192
    buffer_load_dwordx4 v3, s[8:11], s45 offen sc1 lds
    s_add_u32 m0, s56, 9216
    s_add_u32 s45, s57, 9216
    buffer_load_dwordx4 v3, s[8:11], s45 offen sc1 lds
    s_add_u32 m0, s56, 10240
    s_add_u32 s45, s57, 10240
    buffer_load_dwordx4 v3, s[8:11], s45 offen sc1 lds
    s_add_u32 m0, s56, 11264
    s_add_u32 s45, s57, 11264
    buffer_load_dwordx4 v3, s[8:11], s45 offen sc1 lds
    s_cmp_lg_u32 s2, 0
    s_cbranch_scc1 P3_noep
    s_mov_b32 s43, 31457280
    s_cmp_lg_u32 s24, 0
    s_cbranch_scc1 L_ep_nf
    v_mov_b32 v5, s3
    v_mov_b32 v6, 0
    s_mov_b64 exec, 1
    buffer_store_dword v5, v6, s[8:11], s43 offen sc1
    s_mov_b64 exec, -1
L_ep_nf:
P3_noep:
    ds_read_b64_tr_b16 v[128:129], v9 offset:0
    ds_read_b64_tr_b16 v[130:131], v9 offset:1024
    ds_read_b64_tr_b16 v[132:133], v9 offset:2048
    ds_read_b64_tr_b16 v[134:135], v9 offset:3072
    ds_read_b64_tr_b16 v[136:137], v9 offset:4096
    ds_read_b64_tr_b16 v[138:139], v9 offset:5120
    ds_read_b64_tr_b16 v[140:141], v9 offset:6144
    ds_read_b64_tr_b16 v[142:143], v9 offset:7168
    s_waitcnt lgkmcnt(4)
    ds_read_b64_tr_b16 v[144:145], v9 offset:8192
    ds_read_b64_tr_b16 v[146:147], v9 offset:9216
    ds_read_b64_tr_b16 v[148:149], v9 offset:10240
    ds_read_b64_tr_b16 v[150:151], v9 offset:11264
    ds_read_b64_tr_b16 v[152:153], v9 offset:12288
    ds_read_b64_tr_b16 v[154:155], v9 offset:13312
    ds_read_b64_tr_b16 v[156:157], v9 offset:14336
    ds_read_b64_tr_b16 v[158:159], v9 offset:15360
    s_waitcnt lgkmcnt(4)
    ds_read_b64_tr_b16 v[160:161], v9 offset:16384
    ds_read_b64_tr_b16 v[162:163], v9 offset:17408
    ds_read_b64_tr_b16 v[164:165], v9 offset:18432
    ds_read_b64_tr_b16 v[166:167], v9 offset:19456
    ds_read_b64_tr_b16 v[168:169], v9 offset:20480
    ds_read_b64_tr_b16 v[170:171], v9 offset:21504
    ds_read_b64_tr_b16 v[172:173], v9 offset:22528
    ds_read_b64_tr_b16 v[174:175], v9 offset:23552
    s_waitcnt lgkmcnt(4)
    ds_read_b64_tr_b16 v[176:177], v9 offset:24576
    ds_read_b64_tr_b16 v[178:179], v9 offset:25600
    ds_read_b64_tr_b16 v[180:181], v9 offset:26624
    ds_read_b64_tr_b16 v[182:183], v9 offset:27648
    ds_read_b64_tr_b16 v[184:185], v9 offset:28672
    ds_read_b64_tr_b16 v[186:187], v9 offset:29696
    ds_read_b64_tr_b16 v[188:189], v9 offset:30720
    ds_read_b64_tr_b16 v[190:191], v9 offset:31744
    s_waitcnt lgkmcnt(4)
    s_waitcnt vmcnt(4) lgkmcnt(0)
    s_barrier
    ds_read_b128 v[64:67], v11 offset:0
    ds_read_b128 v[68:71], v11 offset:1024
    ds_read_b128 v[72:75], v11 offset:2048
    ds_read_b128 v[76:79], v11 offset:3072
    s_waitcnt lgkmcnt(3)
    v_mfma_f32_32x32x16_bf16 v[16:31], v[128:131], v[64:67], v[16:31]
    ds_read_b128 v[64:67], v11 offset:4096
    s_waitcnt lgkmcnt(3)
    v_mfma_f32_32x32x16_bf16 v[16:31], v[132:135], v[68:71], v[16:31]
    ds_read_b128 v[68:71], v11 offset:5120
    s_waitcnt lgkmcnt(3)
    v_mfma_f32_32x32x16_bf16 v[16:31], v[136:139], v[72:75], v[16:31]
    ds_read_b128 v[72:75], v11 offset:6144
    s_waitcnt lgkmcnt(3)
    v_mfma_f32_32x32x16_bf16 v[16:31], v[140:143], v[76:79], v[16:31]
    ds_read_b128 v[76:79], v11 offset:7168
    s_waitcnt lgkmcnt(3)
    v_mfma_f32_32x32x16_bf16 v[16:31], v[144:147], v[64:67], v[16:31]
    s_waitcnt lgkmcnt(2)
    v_mfma_f32_32x32x16_bf16 v[16:31], v[148:151], v[68:71], v[16:31]
    s_waitcnt lgkmcnt(1)
    v_mfma_f32_32x32x16_bf16 v[16:31], v[152:155], v[72:75], v[16:31]
    s_waitcnt lgkmcnt(0)
    v_mfma_f32_32x32x16_bf16 v[16:31], v[156:159], v[76:79], v[16:31]
    s_waitcnt vmcnt(0) lgkmcnt(0)
    s_barrier
    ds_read_b128 v[64:67], v11 offset:8192
    ds_read_b128 v[68:71], v11 offset:9216
    ds_read_b128 v[72:75], v11 offset:10240
    ds_read_b128 v[76:79], v11 offset:11264
    s_waitcnt lgkmcnt(3)
    v_mfma_f32_32x32x16_bf16 v[16:31], v[160:163], v[64:67], v[16:31]
    ds_read_b128 v[64:67], v11 offset:12288
    s_waitcnt lgkmcnt(3)
    v_mfma_f32_32x32x16_bf16 v[16:31], v[164:167], v[68:71], v[16:31]
    ds_read_b128 v[68:71], v11 offset:13312
    s_waitcnt lgkmcnt(3)
    v_mfma_f32_32x32x16_bf16 v[16:31], v[168:171], v[72:75], v[16:31]
    ds_read_b128 v[72:75], v11 offset:14336
    s_waitcnt lgkmcnt(3)
    v_mfma_f32_32x32x16_bf16 v[16:31], v[172:175], v[76:79], v[16:31]
    ds_read_b128 v[76:79], v11 offset:15360
    s_waitcnt lgkmcnt(3)
    v_mfma_f32_32x32x16_bf16 v[16:31], v[176:179], v[64:67], v[16:31]
    s_waitcnt lgkmcnt(2)
    v_mfma_f32_32x32x16_bf16 v[16:31], v[180:183], v[68:71], v[16:31]
    s_waitcnt lgkmcnt(1)
    v_mfma_f32_32x32x16_bf16 v[16:31], v[184:187], v[72:75], v[16:31]
    s_waitcnt lgkmcnt(0)
    v_mfma_f32_32x32x16_bf16 v[16:31], v[188:191], v[76:79], v[16:31]
    s_nop 7
    s_nop 3
    v_sub_f32 v16, v16, v48
    v_sub_f32 v17, v17, v49
    v_sub_f32 v18, v18, v50
    v_sub_f32 v19, v19, v51
    v_sub_f32 v20, v20, v52
    v_sub_f32 v21, v21, v53
    v_sub_f32 v22, v22, v54
    v_sub_f32 v23, v23, v55
    v_sub_f32 v24, v24, v56
    v_sub_f32 v25, v25, v57
    v_sub_f32 v26, v26, v58
    v_sub_f32 v27, v27, v59
    v_sub_f32 v28, v28, v60
    v_sub_f32 v29, v29, v61
    v_sub_f32 v30, v30, v62
    v_sub_f32 v31, v31, v63
    v_fma_f32 v16, v14, v16, v48
    v_fma_f32 v17, v14, v17, v49
    v_fma_f32 v18, v14, v18, v50
    v_fma_f32 v19, v14, v19, v51
    v_fma_f32 v20, v14, v20, v52
    v_fma_f32 v21, v14, v21, v53
    v_fma_f32 v22, v14, v22, v54
    v_fma_f32 v23, v14, v23, v55
    v_fma_f32 v24, v14, v24, v56
    v_fma_f32 v25, v14, v25, v57
    v_fma_f32 v26, v14, v26, v58
    v_fma_f32 v27, v14, v27, v59
    v_fma_f32 v28, v14, v28, v60
    v_fma_f32 v29, v14, v29, v61
    v_fma_f32 v30, v14, v30, v62
    v_fma_f32 v31, v14, v31, v63
    s_lshl_b32 s43, s24, 11
    v_add_u32 v5, s43, v3
    s_xor_b32 s44, s24, 4
    s_lshl_b32 s44, s44, 11
    v_add_u32 v6, s44, v3
    s_cmp_eq_u32 s54, 0
    s_cbranch_scc0 P3_k1
    ds_write_b128 v5, v[24:27]
    ds_write_b128 v5, v[28:31] offset:1024
    s_waitcnt lgkmcnt(0)
    s_barrier
    ds_read_b128 v[32:35], v6
    ds_read_b128 v[36:39], v6 offset:1024
    s_waitcnt lgkmcnt(0)
    v_add_f32 v16, v16, v32
    v_add_f32 v17, v17, v33
    v_add_f32 v18, v18, v34
    v_add_f32 v19, v19, v35
    v_add_f32 v20, v20, v36
    v_add_f32 v21, v21, v37
    v_add_f32 v22, v22, v38
    v_add_f32 v23, v23, v39
    v_cvt_pk_bf16_f32 v40, v16, v17
    v_cvt_pk_bf16_f32 v41, v18, v19
    v_cvt_pk_bf16_f32 v42, v20, v21
    v_cvt_pk_bf16_f32 v43, v22, v23
    s_branch P3_kdone
P3_k1:
    ds_write_b128 v5, v[16:19]
    ds_write_b128 v5, v[20:23] offset:1024
    s_waitcnt lgkmcnt(0)
    s_barrier
    ds_read_b128 v[32:35], v6
    ds_read_b128 v[36:39], v6 offset:1024
    s_waitcnt lgkmcnt(0)
    v_add_f32 v24, v24, v32
    v_add_f32 v25, v25, v33
    v_add_f32 v26, v26, v34
    v_add_f32 v27, v27, v35
    v_add_f32 v28, v28, v36
    v_add_f32 v29, v29, v37
    v_add_f32 v30, v30, v38
    v_add_f32 v31, v31, v39
    v_cvt_pk_bf16_f32 v40, v24, v25
    v_cvt_pk_bf16_f32 v41, v26, v27
    v_cvt_pk_bf16_f32 v42, v28, v29
    v_cvt_pk_bf16_f32 v43, v30, v31
P3_kdone:
    s_nop 1
    v_permlane32_swap_b32 v40, v42
    v_permlane32_swap_b32 v41, v43
    v_lshlrev_b32 v5, 10, v12
    v_lshl_add_u32 v5, v8, 4, v5
    s_lshl_b32 s42, s51, 7
    s_lshl_b32 s43, s53, 6
    s_add_u32 s42, s42, s43
    s_lshl_b32 s43, s54, 5
    s_add_u32 s42, s42, s43
    buffer_store_dwordx4 v[40:43], v5, s[20:23], s42 offen
    s_endpgm
P1_st_safe0:
    buffer_store_dwordx4 v[128:131], v24, s[8:11], s45 offen sc1
    buffer_store_dwordx4 v[132:135], v24, s[8:11], s45 offen offset:1024 sc1
    buffer_store_dwordx4 v[136:139], v24, s[8:11], s47 offen sc1
    buffer_store_dwordx4 v[140:143], v24, s[8:11], s47 offen offset:1024 sc1
    buffer_store_dwordx4 v[144:147], v24, s[8:11], s46 offen sc1
    buffer_store_dwordx4 v[148:151], v24, s[8:11], s46 offen offset:1024 sc1
    s_nop 1
    s_branch P1_st_done0
P1_st_safe1:
    buffer_store_dwordx4 v[152:155], v24, s[8:11], s45 offen sc1
    buffer_store_dwordx4 v[156:159], v24, s[8:11], s45 offen offset:1024 sc1
    buffer_store_dwordx4 v[160:163], v24, s[8:11], s47 offen sc1
    buffer_store_dwordx4 v[164:167], v24, s[8:11], s47 offen offset:1024 sc1
    buffer_store_dwordx4 v[168:171], v24, s[8:11], s46 offen sc1
    buffer_store_dwordx4 v[172:175], v24, s[8:11], s46 offen offset:1024 sc1
    s_nop 1
    s_branch P1_st_done1
B_jump:
    s_mov_b32 s58, s56
    s_mov_b32 s59, s57
    s_mov_b32 s60, s53
B_skipdma:
    s_add_u32 m0, s58, 0
    s_add_u32 s45, s59, 4194304
    buffer_load_dwordx4 v174, s[8:11], s59 offen sc1 lds
    s_add_u32 m0, s58, 65536
    s_add_u32 s58, s58, 8192
    buffer_load_dwordx4 v174, s[8:11], s45 offen sc1 lds
    s_add_u32 s59, s59, 8192
    s_sub_u32 s60, s60, 1
    s_cmp_lg_u32 s60, 0
    s_cbranch_scc1 B_skipdma
    s_cmp_eq_u32 s53, 1
    s_cbranch_scc1 B_pro1
    s_cmp_eq_u32 s53, 2
    s_cbranch_scc1 B_pro2
    s_cmp_eq_u32 s53, 3
    s_cbranch_scc1 B_pro3
    s_cmp_eq_u32 s53, 4
    s_cbranch_scc1 B_pro4
    s_cmp_eq_u32 s53, 5
    s_cbranch_scc1 B_pro5
    s_cmp_eq_u32 s53, 6
    s_cbranch_scc1 B_pro6
    s_cmp_eq_u32 s53, 7
    s_cbranch_scc1 B_pro7
B_pro8:
    ds_read_b128 v[88:91], v172 offset:8192
    s_waitcnt lgkmcnt(0)
    v_mfma_f32_32x32x16_bf16 v[48:63], v[88:91], v[12:15], v[156:171]
    s_mov_b64 exec, s[40:41]
    ds_read_b128 v[210:213], v173 offset:8192
    ds_read_b128 v[214:217], v173 offset:8704
    s_mov_b64 exec, -1
    s_nop 7
    s_nop 3
    s_branch B_step8
B_pro7:
    ds_read_b128 v[92:95], v172 offset:7168
    s_waitcnt lgkmcnt(0)
    v_mfma_f32_32x32x16_bf16 v[64:79], v[92:95], v[12:15], 0
    ds_read_b128 v[88:91], v172 offset:8192
    s_mov_b64 exec, s[40:41]
    ds_read_b128 v[218:221], v173 offset:7168
    ds_read_b128 v[222:225], v173 offset:7680
    s_mov_b64 exec, -1
    s_nop 7
    s_nop 3
    s_branch B_step7
B_pro6:
    ds_read_b128 v[88:91], v172 offset:6144
    s_waitcnt lgkmcnt(0)
    v_mfma_f32_32x32x16_bf16 v[48:63], v[88:91], v[12:15], 0
    ds_read_b128 v[92:95], v172 offset:7168
    s_mov_b64 exec, s[40:41]
    ds_read_b128 v[210:213], v173 offset:6144
    ds_read_b128 v[214:217], v173 offset:6656
    s_mov_b64 exec, -1
    s_nop 7
    s_nop 3
    s_branch B_step6
B_pro5:
    ds_read_b128 v[92:95], v172 offset:5120
    s_waitcnt lgkmcnt(0)
    v_mfma_f32_32x32x16_bf16 v[64:79], v[92:95], v[12:15], 0
    ds_read_b128 v[88:91], v172 offset:6144
    s_mov_b64 exec, s[40:41]
    ds_read_b128 v[218:221], v173 offset:5120
    ds_read_b128 v[222:225], v173 offset:5632
    s_mov_b64 exec, -1
    s_nop 7
    s_nop 3
    s_branch B_step5
B_pro4:
    ds_read_b128 v[88:91], v172 offset:4096
    s_waitcnt lgkmcnt(0)
    v_mfma_f32_32x32x16_bf16 v[48:63], v[88:91], v[12:15], 0
    ds_read_b128 v[92:95], v172 offset:5120
    s_mov_b64 exec, s[40:41]
    ds_read_b128 v[210:213], v173 offset:4096
    ds_read_b128 v[214:217], v173 offset:4608
    s_mov_b64 exec, -1
    s_nop 7
    s_nop 3
    s_branch B_step4
B_pro3:
    ds_read_b128 v[92:95], v172 offset:3072
    s_waitcnt lgkmcnt(0)
    v_mfma_f32_32x32x16_bf16 v[64:79], v[92:95], v[12:15], 0
    ds_read_b128 v[88:91], v172 offset:4096
    s_mov_b64 exec, s[40:41]
    ds_read_b128 v[218:221], v173 offset:3072
    ds_read_b128 v[222:225], v173 offset:3584
    s_mov_b64 exec, -1
    s_nop 7
    s_nop 3
    s_branch B_step3
B_pro2:
    ds_read_b128 v[88:91], v172 offset:2048
    s_waitcnt lgkmcnt(0)
    v_mfma_f32_32x32x16_bf16 v[48:63], v[88:91], v[12:15], 0
    ds_read_b128 v[92:95], v172 offset:3072
    s_mov_b64 exec, s[40:41]
    ds_read_b128 v[210:213], v173 offset:2048
    ds_read_b128 v[214:217], v173 offset:2560
    s_mov_b64 exec, -1
    s_nop 7
    s_nop 3
    s_branch B_step2
B_pro1:
    ds_read_b128 v[92:95], v172 offset:1024
    s_waitcnt lgkmcnt(0)
    v_mfma_f32_32x32x16_bf16 v[64:79], v[92:95], v[12:15], 0
    ds_read_b128 v[88:91], v172 offset:2048
    s_mov_b64 exec, s[40:41]
    ds_read_b128 v[218:221], v173 offset:1024
    ds_read_b128 v[222:225], v173 offset:1536
    s_mov_b64 exec, -1
    s_nop 7
    s_nop 3
    s_branch B_step1
B_slow:
    v_mov_b32 v182, v180
    v_mov_b32 v183, v181
    s_mov_b32 s60, 0
    v_mov_b32 v179, 0xf1800000
    v_mov_b32 v178, 0
L_bf1_loop:
    ds_read_b128 v[88:91], v182
    s_cmp_eq_u32 s60, 0
    s_cselect_b32 s61, s50, 0
    s_cmp_lg_u32 s61, 0
    s_cbranch_scc1 L_bf1_far
    s_add_u32 s61, s60, 1
    s_cmp_eq_u32 s61, s52
    s_cselect_b32 s61, s51, 0
    s_cmp_lg_u32 s61, 0
    s_cbranch_scc1 L_bf1_diag
    v_mov_b32 v64, v178
    v_mov_b32 v65, v178
    v_mov_b32 v66, v178
    v_mov_b32 v67, v178
    v_mov_b32 v68, v178
    v_mov_b32 v69, v178
    v_mov_b32 v70, v178
    v_mov_b32 v71, v178
    v_mov_b32 v72, v178
    v_mov_b32 v73, v178
    v_mov_b32 v74, v178
    v_mov_b32 v75, v178
    v_mov_b32 v76, v178
    v_mov_b32 v77, v178
    v_mov_b32 v78, v178
    v_mov_b32 v79, v178
    s_branch L_bf1_go
L_bf1_far:
    v_add_f32 v64, v140, v178
    v_add_f32 v65, v141, v178
    v_add_f32 v66, v142, v178
    v_add_f32 v67, v143, v178
    v_add_f32 v68, v144, v178
    v_add_f32 v69, v145, v178
    v_add_f32 v70, v146, v178
    v_add_f32 v71, v147, v178
    v_add_f32 v72, v148, v178
    v_add_f32 v73, v149, v178
    v_add_f32 v74, v150, v178
    v_add_f32 v75, v151, v178
    v_add_f32 v76, v152, v178
    v_add_f32 v77, v153, v178
    v_add_f32 v78, v154, v178
    v_add_f32 v79, v155, v178
    s_branch L_bf1_go
L_bf1_diag:
    v_add_f32 v64, v156, v178
    v_add_f32 v65, v157, v178
    v_add_f32 v66, v158, v178
    v_add_f32 v67, v159, v178
    v_add_f32 v68, v160, v178
    v_add_f32 v69, v161, v178
    v_add_f32 v70, v162, v178
    v_add_f32 v71, v163, v178
    v_add_f32 v72, v164, v178
    v_add_f32 v73, v165, v178
    v_add_f32 v74, v166, v178
    v_add_f32 v75, v167, v178
    v_add_f32 v76, v168, v178
    v_add_f32 v77, v169, v178
    v_add_f32 v78, v170, v178
    v_add_f32 v79, v171, v178
L_bf1_go:
    s_waitcnt lgkmcnt(0)
    s_nop 0
    v_mfma_f32_32x32x16_bf16 v[48:63], v[88:91], v[12:15], v[64:79]
    s_nop 7
    s_nop 3
    v_max_f32 v179, v179, v48
    v_max_f32 v179, v179, v49
    v_max_f32 v179, v179, v50
    v_max_f32 v179, v179, v51
    v_max_f32 v179, v179, v52
    v_max_f32 v179, v179, v53
    v_max_f32 v179, v179, v54
    v_max_f32 v179, v179, v55
    v_max_f32 v179, v179, v56
    v_max_f32 v179, v179, v57
    v_max_f32 v179, v179, v58
    v_max_f32 v179, v179, v59
    v_max_f32 v179, v179, v60
    v_max_f32 v179, v179, v61
    v_max_f32 v179, v179, v62
    v_max_f32 v179, v179, v63
    v_add_u32 v182, 1024, v182
    v_add_u32 v183, 1024, v183
    s_add_u32 s60, s60, 1
    s_cmp_lt_u32 s60, s52
    s_cbranch_scc1 L_bf1_loop
    v_mov_b32 v175, v179
    s_nop 1
    v_permlane32_swap_b32 v175, v179
    s_nop 1
    v_max_f32 v179, v179, v175
    v_sub_f32 v178, 0, v179
    v_mov_b32 v182, v180
    v_mov_b32 v183, v181
    s_mov_b32 s60, 0
    v_mov_b32 v16, 0
    v_mov_b32 v17, 0
    v_mov_b32 v18, 0
    v_mov_b32 v19, 0
    v_mov_b32 v20, 0
    v_mov_b32 v21, 0
    v_mov_b32 v22, 0
    v_mov_b32 v23, 0
    v_mov_b32 v24, 0
    v_mov_b32 v25, 0
    v_mov_b32 v26, 0
    v_mov_b32 v27, 0
    v_mov_b32 v28, 0
    v_mov_b32 v29, 0
    v_mov_b32 v30, 0
    v_mov_b32 v31, 0
L_bf2_loop:
    ds_read_b128 v[88:91], v182
    s_mov_b64 exec, s[40:41]
    ds_read_b128 v[210:213], v183
    ds_read_b128 v[214:217], v183 offset:512
    s_mov_b64 exec, -1
    s_cmp_eq_u32 s60, 0
    s_cselect_b32 s61, s50, 0
    s_cmp_lg_u32 s61, 0
    s_cbranch_scc1 L_bf2_far
    s_add_u32 s61, s60, 1
    s_cmp_eq_u32 s61, s52
    s_cselect_b32 s61, s51, 0
    s_cmp_lg_u32 s61, 0
    s_cbranch_scc1 L_bf2_diag
    v_mov_b32 v64, v178
    v_mov_b32 v65, v178
    v_mov_b32 v66, v178
    v_mov_b32 v67, v178
    v_mov_b32 v68, v178
    v_mov_b32 v69, v178
    v_mov_b32 v70, v178
    v_mov_b32 v71, v178
    v_mov_b32 v72, v178
    v_mov_b32 v73, v178
    v_mov_b32 v74, v178
    v_mov_b32 v75, v178
    v_mov_b32 v76, v178
    v_mov_b32 v77, v178
    v_mov_b32 v78, v178
    v_mov_b32 v79, v178
    s_branch L_bf2_go
L_bf2_far:
    v_add_f32 v64, v140, v178
    v_add_f32 v65, v141, v178
    v_add_f32 v66, v142, v178
    v_add_f32 v67, v143, v178
    v_add_f32 v68, v144, v178
    v_add_f32 v69, v145, v178
    v_add_f32 v70, v146, v178
    v_add_f32 v71, v147, v178
    v_add_f32 v72, v148, v178
    v_add_f32 v73, v149, v178
    v_add_f32 v74, v150, v178
    v_add_f32 v75, v151, v178
    v_add_f32 v76, v152, v178
    v_add_f32 v77, v153, v178
    v_add_f32 v78, v154, v178
    v_add_f32 v79, v155, v178
    s_branch L_bf2_go
L_bf2_diag:
    v_add_f32 v64, v156, v178
    v_add_f32 v65, v157, v178
    v_add_f32 v66, v158, v178
    v_add_f32 v67, v159, v178
    v_add_f32 v68, v160, v178
    v_add_f32 v69, v161, v178
    v_add_f32 v70, v162, v178
    v_add_f32 v71, v163, v178
    v_add_f32 v72, v164, v178
    v_add_f32 v73, v165, v178
    v_add_f32 v74, v166, v178
    v_add_f32 v75, v167, v178
    v_add_f32 v76, v168, v178
    v_add_f32 v77, v169, v178
    v_add_f32 v78, v170, v178
    v_add_f32 v79, v171, v178
L_bf2_go:
    s_waitcnt lgkmcnt(0)
    s_nop 0
    v_mfma_f32_32x32x16_bf16 v[48:63], v[88:91], v[12:15], v[64:79]
    s_nop 7
    s_nop 3
    v_exp_f32 v48, v48
    v_exp_f32 v49, v49
    v_exp_f32 v50, v50
    v_exp_f32 v51, v51
    v_exp_f32 v52, v52
    v_exp_f32 v53, v53
    v_exp_f32 v54, v54
    v_exp_f32 v55, v55
    v_exp_f32 v56, v56
    v_exp_f32 v57, v57
    v_exp_f32 v58, v58
    v_exp_f32 v59, v59
    v_exp_f32 v60, v60
    v_exp_f32 v61, v61
    v_exp_f32 v62, v62
    v_exp_f32 v63, v63
    s_nop 0
    v_cvt_pk_bf16_f32 v80, v48, v49
    v_cvt_pk_bf16_f32 v81, v50, v51
    v_cvt_pk_bf16_f32 v82, v52, v53
    v_cvt_pk_bf16_f32 v83, v54, v55
    v_cvt_pk_bf16_f32 v84, v56, v57
    v_cvt_pk_bf16_f32 v85, v58, v59
    v_cvt_pk_bf16_f32 v86, v60, v61
    v_cvt_pk_bf16_f32 v87, v62, v63
    s_nop 1
    v_mfma_f32_32x32x16_bf16 v[16:31], v[210:213], v[80:83], v[16:31]
    v_mfma_f32_32x32x16_bf16 v[16:31], v[214:217], v[84:87], v[16:31]
    v_add_u32 v182, 1024, v182
    v_add_u32 v183, 1024, v183
    s_add_u32 s60, s60, 1
    s_cmp_lt_u32 s60, s52
    s_cbranch_scc1 L_bf2_loop
    s_nop 7
    s_nop 3
    v_mov_b32 v175, v24
    s_nop 1
    v_permlane32_swap_b32 v175, v24
    s_nop 1
    v_add_f32 v24, v24, v175
    s_branch B_ok
A_mid:
    s_cmp_eq_u32 s53, 4
    s_cbranch_scc0 A_mid1
    s_waitcnt vmcnt(0)
    ds_read_b64_tr_b16 v[96:97], v191 offset:0
    ds_read_b64_tr_b16 v[98:99], v191 offset:512
    ds_read_b64_tr_b16 v[100:101], v191 offset:1024
    ds_read_b64_tr_b16 v[102:103], v191 offset:1536
    ds_read_b64_tr_b16 v[104:105], v191 offset:2048
    ds_read_b64_tr_b16 v[106:107], v191 offset:2560
    ds_read_b64_tr_b16 v[108:109], v191 offset:3072
    ds_read_b64_tr_b16 v[110:111], v191 offset:3584
    s_waitcnt lgkmcnt(0)
    s_add_u32 m0, s83, 0
    s_add_u32 s45, s82, 0
    buffer_load_dwordx4 v190, s[12:15], s45 offen lds
    s_add_u32 m0, s83, 1024
    s_add_u32 s45, s82, 16384
    buffer_load_dwordx4 v190, s[12:15], s45 offen lds
    s_add_u32 m0, s83, 2048
    s_add_u32 s45, s82, 32768
    buffer_load_dwordx4 v190, s[12:15], s45 offen lds
    s_add_u32 m0, s83, 3072
    s_add_u32 s45, s82, 49152
    buffer_load_dwordx4 v190, s[12:15], s45 offen lds
    s_add_u32 s82, s82, 65536
    s_branch A_midback
A_mid1:
    s_waitcnt vmcnt(0)
    ds_read_b64_tr_b16 v[136:137], v191 offset:0
    ds_read_b64_tr_b16 v[138:139], v191 offset:512
    ds_read_b64_tr_b16 v[192:193], v191 offset:1024
    ds_read_b64_tr_b16 v[194:195], v191 offset:1536
    ds_read_b64_tr_b16 v[196:197], v191 offset:2048
    ds_read_b64_tr_b16 v[198:199], v191 offset:2560
    ds_read_b64_tr_b16 v[200:201], v191 offset:3072
    ds_read_b64_tr_b16 v[202:203], v191 offset:3584
    s_waitcnt lgkmcnt(0)
    s_add_u32 m0, s83, 0
    s_add_u32 s45, s82, 0
    buffer_load_dwordx4 v190, s[12:15], s45 offen lds
    s_add_u32 m0, s83, 1024
    s_add_u32 s45, s82, 16384
    buffer_load_dwordx4 v190, s[12:15], s45 offen lds
    s_add_u32 m0, s83, 2048
    s_add_u32 s45, s82, 32768
    buffer_load_dwordx4 v190, s[12:15], s45 offen lds
    s_add_u32 m0, s83, 3072
    s_add_u32 s45, s82, 49152
    buffer_load_dwordx4 v190, s[12:15], s45 offen lds
    s_add_u32 s82, s82, 65536
    s_branch A_midback
A_it1:
    s_setprio 2
    s_waitcnt vmcnt(0)
    ds_read_b64_tr_b16 v[120:121], v191 offset:0
    ds_read_b64_tr_b16 v[122:123], v191 offset:512
    ds_read_b64_tr_b16 v[124:125], v191 offset:1024
    ds_read_b64_tr_b16 v[126:127], v191 offset:1536
    ds_read_b64_tr_b16 v[128:129], v191 offset:2048
    ds_read_b64_tr_b16 v[130:131], v191 offset:2560
    ds_read_b64_tr_b16 v[132:133], v191 offset:3072
    ds_read_b64_tr_b16 v[134:135], v191 offset:3584
    s_waitcnt lgkmcnt(0)
    s_mov_b64 exec, 1
    buffer_store_dword v112, v113, s[8:11], s34 offen sc1
    s_mov_b64 exec, -1
    s_add_u32 m0, s83, 0
    s_add_u32 s45, s82, 0
    buffer_load_dwordx4 v190, s[12:15], s45 offen lds
    s_add_u32 m0, s83, 1024
    s_add_u32 s45, s82, 16384
    buffer_load_dwordx4 v190, s[12:15], s45 offen lds
    s_add_u32 m0, s83, 2048
    s_add_u32 s45, s82, 32768
    buffer_load_dwordx4 v190, s[12:15], s45 offen lds
    s_add_u32 m0, s83, 3072
    s_add_u32 s45, s82, 49152
    buffer_load_dwordx4 v190, s[12:15], s45 offen lds
    s_add_u32 s82, s82, 65536
    s_branch A_body
A_it2:
    s_setprio 1
    s_waitcnt vmcnt(0)
    ds_read_b64_tr_b16 v[204:205], v191 offset:0
    ds_read_b64_tr_b16 v[206:207], v191 offset:512
    ds_read_b64_tr_b16 v[228:229], v191 offset:1024
    ds_read_b64_tr_b16 v[230:231], v191 offset:1536
    ds_read_b64_tr_b16 v[232:233], v191 offset:2048
    ds_read_b64_tr_b16 v[234:235], v191 offset:2560
    ds_read_b64_tr_b16 v[236:237], v191 offset:3072
    ds_read_b64_tr_b16 v[238:239], v191 offset:3584
    s_waitcnt lgkmcnt(0)
    s_cmp_lg_u32 s26, 0
    s_cbranch_scc1 A_nowb
    s_cmp_lg_u32 s24, 0
    s_cbranch_scc1 A_nowb
    buffer_wbl2 sc1
A_nowb:
    s_and_b32 s44, s26, 3
    s_lshr_b32 s45, s26, 2
    s_lshl_b32 s46, s44, 7
    s_lshl_b32 s47, s24, 4
    s_add_u32 s46, s46, s47
    v_and_b32 v116, 15, v1
    v_add_u32 v116, s46, v116
    v_lshlrev_b32 v116, 10, v116
    s_lshl_b32 s45, s45, 7
    s_mov_b32 s56, s84
    s_mov_b32 s57, s85
    s_mov_b32 s58, 524288
    s_mov_b32 s59, 0x00020000
    buffer_load_dword v117, v116, s[56:59], s45 offen
    s_branch A_body
A_it3:
    s_setprio 0
    buffer_load_dword v115, v114, s[8:11], s36 offen sc1
    s_branch A_body
A_slow:
    s_mov_b32 s50, 0
    s_mov_b32 s51, 0
    s_mov_b32 s52, 64
    v_add_u32 v180, 0, v174
    v_add_u32 v181, 65536, v188
    v_mov_b32 v182, v180
    v_mov_b32 v183, v181
    s_mov_b32 s60, 0
    v_mov_b32 v179, 0xf1800000
    v_mov_b32 v178, 0
L_af1_loop:
    ds_read_b128 v[88:91], v182
    s_cmp_eq_u32 s60, 0
    s_cselect_b32 s61, s50, 0
    s_cmp_lg_u32 s61, 0
    s_cbranch_scc1 L_af1_far
    s_add_u32 s61, s60, 1
    s_cmp_eq_u32 s61, s52
    s_cselect_b32 s61, s51, 0
    s_cmp_lg_u32 s61, 0
    s_cbranch_scc1 L_af1_diag
    v_mov_b32 v64, v178
    v_mov_b32 v65, v178
    v_mov_b32 v66, v178
    v_mov_b32 v67, v178
    v_mov_b32 v68, v178
    v_mov_b32 v69, v178
    v_mov_b32 v70, v178
    v_mov_b32 v71, v178
    v_mov_b32 v72, v178
    v_mov_b32 v73, v178
    v_mov_b32 v74, v178
    v_mov_b32 v75, v178
    v_mov_b32 v76, v178
    v_mov_b32 v77, v178
    v_mov_b32 v78, v178
    v_mov_b32 v79, v178
    s_branch L_af1_go
L_af1_far:
    v_add_f32 v64, v140, v178
    v_add_f32 v65, v141, v178
    v_add_f32 v66, v142, v178
    v_add_f32 v67, v143, v178
    v_add_f32 v68, v144, v178
    v_add_f32 v69, v145, v178
    v_add_f32 v70, v146, v178
    v_add_f32 v71, v147, v178
    v_add_f32 v72, v148, v178
    v_add_f32 v73, v149, v178
    v_add_f32 v74, v150, v178
    v_add_f32 v75, v151, v178
    v_add_f32 v76, v152, v178
    v_add_f32 v77, v153, v178
    v_add_f32 v78, v154, v178
    v_add_f32 v79, v155, v178
    s_branch L_af1_go
L_af1_diag:
    v_add_f32 v64, v156, v178
    v_add_f32 v65, v157, v178
    v_add_f32 v66, v158, v178
    v_add_f32 v67, v159, v178
    v_add_f32 v68, v160, v178
    v_add_f32 v69, v161, v178
    v_add_f32 v70, v162, v178
    v_add_f32 v71, v163, v178
    v_add_f32 v72, v164, v178
    v_add_f32 v73, v165, v178
    v_add_f32 v74, v166, v178
    v_add_f32 v75, v167, v178
    v_add_f32 v76, v168, v178
    v_add_f32 v77, v169, v178
    v_add_f32 v78, v170, v178
    v_add_f32 v79, v171, v178
L_af1_go:
    s_waitcnt lgkmcnt(0)
    s_nop 0
    v_mfma_f32_32x32x16_bf16 v[48:63], v[88:91], v[4:7], v[64:79]
    s_nop 7
    s_nop 3
    v_max_f32 v179, v179, v48
    v_max_f32 v179, v179, v49
    v_max_f32 v179, v179, v50
    v_max_f32 v179, v179, v51
    v_max_f32 v179, v179, v52
    v_max_f32 v179, v179, v53
    v_max_f32 v179, v179, v54
    v_max_f32 v179, v179, v55
    v_max_f32 v179, v179, v56
    v_max_f32 v179, v179, v57
    v_max_f32 v179, v179, v58
    v_max_f32 v179, v179, v59
    v_max_f32 v179, v179, v60
    v_max_f32 v179, v179, v61
    v_max_f32 v179, v179, v62
    v_max_f32 v179, v179, v63
    v_add_u32 v182, 1024, v182
    v_add_u32 v183, 1024, v183
    s_add_u32 s60, s60, 1
    s_cmp_lt_u32 s60, s52
    s_cbranch_scc1 L_af1_loop
    v_mov_b32 v175, v179
    s_nop 1
    v_permlane32_swap_b32 v175, v179
    s_nop 1
    v_max_f32 v179, v179, v175
    v_sub_f32 v178, 0, v179
    v_mov_b32 v182, v180
    v_mov_b32 v183, v181
    s_mov_b32 s60, 0
    v_mov_b32 v16, 0
    v_mov_b32 v17, 0
    v_mov_b32 v18, 0
    v_mov_b32 v19, 0
    v_mov_b32 v20, 0
    v_mov_b32 v21, 0
    v_mov_b32 v22, 0
    v_mov_b32 v23, 0
    v_mov_b32 v24, 0
    v_mov_b32 v25, 0
    v_mov_b32 v26, 0
    v_mov_b32 v27, 0
    v_mov_b32 v28, 0
    v_mov_b32 v29, 0
    v_mov_b32 v30, 0
    v_mov_b32 v31, 0
L_af2_loop:
    ds_read_b128 v[88:91], v182
    s_mov_b64 exec, s[40:41]
    ds_read_b128 v[210:213], v183
    ds_read_b128 v[214:217], v183 offset:512
    s_mov_b64 exec, -1
    s_cmp_eq_u32 s60, 0
    s_cselect_b32 s61, s50, 0
    s_cmp_lg_u32 s61, 0
    s_cbranch_scc1 L_af2_far
    s_add_u32 s61, s60, 1
    s_cmp_eq_u32 s61, s52
    s_cselect_b32 s61, s51, 0
    s_cmp_lg_u32 s61, 0
    s_cbranch_scc1 L_af2_diag
    v_mov_b32 v64, v178
    v_mov_b32 v65, v178
    v_mov_b32 v66, v178
    v_mov_b32 v67, v178
    v_mov_b32 v68, v178
    v_mov_b32 v69, v178
    v_mov_b32 v70, v178
    v_mov_b32 v71, v178
    v_mov_b32 v72, v178
    v_mov_b32 v73, v178
    v_mov_b32 v74, v178
    v_mov_b32 v75, v178
    v_mov_b32 v76, v178
    v_mov_b32 v77, v178
    v_mov_b32 v78, v178
    v_mov_b32 v79, v178
    s_branch L_af2_go
L_af2_far:
    v_add_f32 v64, v140, v178
    v_add_f32 v65, v141, v178
    v_add_f32 v66, v142, v178
    v_add_f32 v67, v143, v178
    v_add_f32 v68, v144, v178
    v_add_f32 v69, v145, v178
    v_add_f32 v70, v146, v178
    v_add_f32 v71, v147, v178
    v_add_f32 v72, v148, v178
    v_add_f32 v73, v149, v178
    v_add_f32 v74, v150, v178
    v_add_f32 v75, v151, v178
    v_add_f32 v76, v152, v178
    v_add_f32 v77, v153, v178
    v_add_f32 v78, v154, v178
    v_add_f32 v79, v155, v178
    s_branch L_af2_go
L_af2_diag:
    v_add_f32 v64, v156, v178
    v_add_f32 v65, v157, v178
    v_add_f32 v66, v158, v178
    v_add_f32 v67, v159, v178
    v_add_f32 v68, v160, v178
    v_add_f32 v69, v161, v178
    v_add_f32 v70, v162, v178
    v_add_f32 v71, v163, v178
    v_add_f32 v72, v164, v178
    v_add_f32 v73, v165, v178
    v_add_f32 v74, v166, v178
    v_add_f32 v75, v167, v178
    v_add_f32 v76, v168, v178
    v_add_f32 v77, v169, v178
    v_add_f32 v78, v170, v178
    v_add_f32 v79, v171, v178
L_af2_go:
    s_waitcnt lgkmcnt(0)
    s_nop 0
    v_mfma_f32_32x32x16_bf16 v[48:63], v[88:91], v[4:7], v[64:79]
    s_nop 7
    s_nop 3
    v_exp_f32 v48, v48
    v_exp_f32 v49, v49
    v_exp_f32 v50, v50
    v_exp_f32 v51, v51
    v_exp_f32 v52, v52
    v_exp_f32 v53, v53
    v_exp_f32 v54, v54
    v_exp_f32 v55, v55
    v_exp_f32 v56, v56
    v_exp_f32 v57, v57
    v_exp_f32 v58, v58
    v_exp_f32 v59, v59
    v_exp_f32 v60, v60
    v_exp_f32 v61, v61
    v_exp_f32 v62, v62
    v_exp_f32 v63, v63
    s_nop 0
    v_cvt_pk_bf16_f32 v80, v48, v49
    v_cvt_pk_bf16_f32 v81, v50, v51
    v_cvt_pk_bf16_f32 v82, v52, v53
    v_cvt_pk_bf16_f32 v83, v54, v55
    v_cvt_pk_bf16_f32 v84, v56, v57
    v_cvt_pk_bf16_f32 v85, v58, v59
    v_cvt_pk_bf16_f32 v86, v60, v61
    v_cvt_pk_bf16_f32 v87, v62, v63
    s_nop 1
    v_mfma_f32_32x32x16_bf16 v[16:31], v[210:213], v[80:83], v[16:31]
    v_mfma_f32_32x32x16_bf16 v[16:31], v[214:217], v[84:87], v[16:31]
    v_add_u32 v182, 1024, v182
    v_add_u32 v183, 1024, v183
    s_add_u32 s60, s60, 1
    s_cmp_lt_u32 s60, s52
    s_cbranch_scc1 L_af2_loop
    s_nop 7
    s_nop 3
    v_mov_b32 v175, v24
    s_nop 1
    v_permlane32_swap_b32 v175, v24
    s_nop 1
    v_add_f32 v24, v24, v175
    s_branch A_ok
L_done:
    s_endpgm
.section .rodata,"a"
.p2align 6
.amdhsa_kernel gated_mix__softmax_full_mha__sliding_block__prompt_kernel
  .amdhsa_next_free_vgpr 256
  .amdhsa_next_free_sgpr 102
  .amdhsa_accum_offset 256
  .amdhsa_group_segment_fixed_size 0
  .amdhsa_kernarg_size 80
  .amdhsa_user_sgpr_count 2
  .amdhsa_user_sgpr_kernarg_segment_ptr 1
  .amdhsa_system_sgpr_workgroup_id_x 1
.end_amdhsa_kernel
```
